```python
import torch

def _softmax(x, axis=-1):
    return torch.softmax(x, dim=axis)
def _gelu(x):
    return torch.nn.functional.gelu(x, approximate="tanh")
def _silu(x):
    return torch.nn.functional.silu(x)
def _sigmoid(x):
    return torch.sigmoid(x)
def _layernorm(x, axis=-1, eps=1e-5):
    m = x.mean(dim=axis, keepdim=True)
    v = x.var(dim=axis, keepdim=True, unbiased=False)
    return (x - m) / torch.sqrt(v + eps)
def _scatter_add(tgt, idx, src, axis=0):
    return tgt.clone().index_add_(axis, idx, src)
def _segment_sum(src, seg, n):
    out = torch.zeros((n,) + src.shape[1:], dtype=src.dtype)
    return out.index_add_(0, seg, src)
def _pad(x, pw):
    flat = tuple(v for pair in reversed(pw) for v in pair)
    return torch.nn.functional.pad(x, flat)

kernel_name = 'interleave_layers__ssm_conv_h3__linear_attn_block__prompt'

def setup_inputs():

    _w = (lambda a: (lambda t: t.to(torch.bfloat16) if t.is_floating_point() else t)(torch.as_tensor(a)))
    def _A_setup():
        B, S, D = 1, 2048, 512
        ks = 4
        return {
            "q": _w((lambda *s: torch.randn(*s, dtype=torch.bfloat16) * 0.05)(B, S, D)),
            "k": _w((lambda *s: torch.randn(*s, dtype=torch.bfloat16) * 0.4)(B, S, D)),
            "v": _w((lambda *s: torch.randn(*s, dtype=torch.bfloat16) * 0.4)(B, S, D)),
            "shift_k": _w((lambda *s: torch.randn(*s, dtype=torch.bfloat16) * 0.4)(D, ks) * 0.5),
            "ssm_k": _w((lambda *s: torch.randn(*s, dtype=torch.bfloat16) * 0.4)(D, S) * (1.0 / S ** 0.5)),
            "ssm_D": _w((lambda *s: torch.randn(*s, dtype=torch.bfloat16) * 0.4)(D)),
        }
    _A_in = _A_setup()

    def _B_setup():
        B, S, D = 1, 2048, 512
        return {
            "x": _w((lambda *s: torch.randn(*s, dtype=torch.bfloat16) * 0.05)(B, S, D)),
            "wqkv": _w((lambda *s: torch.randn(*s, dtype=torch.bfloat16) * 0.1)(D, 3 * D)),
            "wo": _w((lambda *s: torch.randn(*s, dtype=torch.bfloat16) * 0.05)(D, D)),
        }
    _B_in = _B_setup()

    return {
        "A_q": _A_in["q"],
        "A_k": _A_in["k"],
        "A_v": _A_in["v"],
        "A_shift_k": _A_in["shift_k"],
        "A_ssm_k": _A_in["ssm_k"],
        "A_ssm_D": _A_in["ssm_D"],
        "B_x": _B_in["x"],
        "B_wqkv": _B_in["wqkv"],
        "B_wo": _B_in["wo"],
    }

def reference(A_q, A_k, A_v, A_shift_k, A_ssm_k, A_ssm_D, B_x, B_wqkv, B_wo):
    def _A_ref(q, k, v, shift_k, ssm_k, ssm_D):
        B, S, D = q.shape
        ks = shift_k.shape[-1]
        k_pad = _pad(k, ((0, 0), (ks - 1, 0), (0, 0)))
        k_shift = torch.zeros_like(k)
        for t in range(ks):
            k_shift = k_shift + k_pad[:, t:t + S, :] * shift_k[:, ks - 1 - t][None, None, :]
        kv = k_shift * v
        L = 2 * S
        kv_pad = _pad(kv, ((0, 0), (0, S), (0, 0)))
        kf_pad = _pad(ssm_k, ((0, 0), (0, S)))
        kv_f = (lambda x, axes=(-2,-1): torch.fft.rfft2(x.float(), dim=axes))(kv_pad[:, None, :, :], axes=(1, 2))
        kf_f = (lambda x, axes=(-2,-1): torch.fft.rfft2(x.float(), dim=axes))(kf_pad[:, None, :], axes=(1, 2))
        kf_f = (lambda x, *d: x.permute(*d))(kf_f, 1, 2, 0)
        y_f = kv_f * kf_f[None, :, :, :]
        y = (lambda x, s, axes=(-2,-1): torch.fft.irfft2(x, s=s, dim=axes).to(torch.bfloat16))(y_f, (1, L), axes=(1, 2))[:, 0, :S, :]
        y = y + kv * ssm_D[None, None, :]
        return q * y

    def _B_ref(x, wqkv, wo):
        B, S, D = x.shape
        H = 32; Dh = D // H
        qkv = (lambda x, *d: x.permute(*d))((x @ wqkv).reshape(B, S, 3, H, Dh), 2, 0, 3, 1, 4)
        q, k, v = qkv[0], qkv[1], qkv[2]
        phi = lambda t: torch.where(t > 0, t + 1, torch.exp(t)) + 1e-6
        pq, pk = phi(q), phi(k)
        kv = torch.einsum("bhsd,bhse->bhde", pk, v)
        z = torch.einsum("bhsd->bhd", pk)
        num = torch.einsum("bhqd,bhde->bhqe", pq, kv)
        den = torch.einsum("bhqd,bhd->bhq", pq, z)[..., None] + 1e-6
        o = num / den
        return (lambda x, *d: x.permute(*d))(o, 0, 2, 1, 3).reshape(B, S, D) @ wo

    x = A_q
    x = x + _A_ref(_layernorm(x, axis=-1), A_k, A_v, A_shift_k, A_ssm_k, A_ssm_D)
    x = x + _B_ref(_layernorm(x, axis=-1), B_wqkv, B_wo)
    x = x + _A_ref(_layernorm(x, axis=-1), A_k, A_v, A_shift_k, A_ssm_k, A_ssm_D)
    x = x + _B_ref(_layernorm(x, axis=-1), B_wqkv, B_wo)
    return x
```

```asm
; @launch grid=(256,1,1) block=(256,1,1) lds=163840
.amdgcn_target "amdgcn-amd-amdhsa--gfx950"
.text
.p2align 15
.globl interleave_layers__ssm_conv_h3__linear_attn_block__prompt_kernel
.p2align 8
.type interleave_layers__ssm_conv_h3__linear_attn_block__prompt_kernel,@function
interleave_layers__ssm_conv_h3__linear_attn_block__prompt_kernel:
    s_cmp_ge_u32 s2, 256
    s_cbranch_scc1 L_exit
    s_load_dwordx2 s[8:9], s[0:1], 8
    s_load_dwordx2 s[12:13], s[0:1], 16
    s_load_dwordx2 s[28:29], s[0:1], 88
    s_load_dwordx2 s[36:37], s[0:1], 24
    s_load_dwordx2 s[16:17], s[0:1], 32
    s_load_dwordx2 s[4:5], s[0:1], 0
    s_load_dwordx2 s[40:41], s[0:1], 40
    s_load_dwordx2 s[20:21], s[0:1], 56
    s_load_dwordx2 s[24:25], s[0:1], 64
    s_load_dwordx2 s[32:33], s[0:1], 72
    s_getpc_b64 s[56:57]
    s_and_b32 s56, s56, 0xffffff00
    s_lshr_b32 s45, s2, 3
    s_lshl_b32 s52, s45, 10
    v_lshl_add_u32 v68, v0, 7, s52
    v_min_u32 v68, L_exit-interleave_layers__ssm_conv_h3__linear_attn_block__prompt_kernel, v68
    v_cmp_gt_u32 vcc, 8, v0
    s_nop 0
    s_and_saveexec_b64 s[70:71], vcc
    s_cbranch_execz L_nopf
    global_load_dword v69, v68, s[56:57]
L_nopf:
    s_mov_b64 exec, -1
    s_and_b32 s44, s2, 7
    v_lshrrev_b32 v70, 6, v0
    v_and_b32_e64 v71, 63, v0
    v_readfirstlane_b32 s46, v70
    s_mov_b32 s10, 2097152
    s_mov_b32 s11, 0x20000
    s_mov_b32 s14, 2097152
    s_mov_b32 s15, 0x20000
    s_mov_b32 s38, 4096
    s_mov_b32 s39, 0x20000
    s_mov_b32 s58, 4096
    s_lshl_b32 s52, s44, 7
    s_lshl_b32 s53, s45, 16
    s_add_u32 s53, s53, s52
    v_and_b32 v75, 31, v0
    v_lshrrev_b32 v72, 5, v0
    v_lshlrev_b32 v72, 13, v72
    v_lshl_add_u32 v73, v75, 2, v72
    v_add_u32 v73, s53, v73
    v_add_u32 v72, 0xfffff400, v73
    v_lshlrev_b32 v74, 4, v75
    s_lshl_b32 s54, s52, 2
    s_lshl_b32 s52, s44, 5
    s_add_u32 s52, s52, s45
    s_lshl_b32 s55, s52, 2
    s_lshl_b32 s52, s52, 13
    v_lshl_add_u32 v184, v0, 4, s52
    v_add_u32 v185, -8, v184
    s_mov_b32 s18, 2097152
    s_mov_b32 s19, 0x20000
    s_waitcnt lgkmcnt(0)
    s_load_dword s60, s[40:41], s55
    s_load_dwordx2 s[42:43], s[28:29], 0
    buffer_load_dwordx4 v[102:105], v184, s[16:19], 0 offen
    buffer_load_dwordx2 v[100:101], v185, s[16:19], 0 offen
    buffer_load_dwordx4 v[108:111], v184, s[16:19], s58 offen
    buffer_load_dwordx2 v[106:107], v185, s[16:19], s58 offen
    buffer_load_dwordx4 v[96:99], v74, s[36:39], s54 offen
    buffer_load_dword v76, v72, s[8:11], 0 offen offset:0
    buffer_load_dword v77, v72, s[8:11], 0 offen offset:1024
    buffer_load_dword v78, v72, s[8:11], 0 offen offset:2048
    buffer_load_dword v79, v73, s[8:11], 0 offen offset:0
    buffer_load_dword v80, v73, s[8:11], 0 offen offset:1024
    buffer_load_dword v81, v73, s[8:11], 0 offen offset:2048
    buffer_load_dword v82, v73, s[8:11], 0 offen offset:3072
    buffer_load_dword v83, v73, s[8:11], s58 offen offset:0
    buffer_load_dword v84, v73, s[8:11], s58 offen offset:1024
    buffer_load_dword v85, v73, s[8:11], s58 offen offset:2048
    buffer_load_dword v86, v73, s[8:11], s58 offen offset:3072
    buffer_load_dword v88, v73, s[12:15], 0 offen offset:0
    buffer_load_dword v89, v73, s[12:15], 0 offen offset:1024
    buffer_load_dword v90, v73, s[12:15], 0 offen offset:2048
    buffer_load_dword v91, v73, s[12:15], 0 offen offset:3072
    buffer_load_dword v92, v73, s[12:15], s58 offen offset:0
    buffer_load_dword v93, v73, s[12:15], s58 offen offset:1024
    buffer_load_dword v94, v73, s[12:15], s58 offen offset:2048
    buffer_load_dword v95, v73, s[12:15], s58 offen offset:3072
    s_mov_b32 s30, 33554432
    s_mov_b32 s31, 0x20000
    s_mov_b32 s6, 2097152
    s_mov_b32 s7, 0x20000
    s_mov_b32 s22, 1572864
    s_mov_b32 s23, 0x20000
    s_lshl_b32 s51, s44, 19
    s_add_u32 s51, s51, 0x600000
    s_lshr_b32 s61, s45, 2
    s_and_b32 s62, s45, 3
    s_lshl_b32 s62, s62, 2
    s_add_u32 s62, s62, s46
    s_lshl_b32 s52, s46, 7
    s_add_u32 s52, s52, s51
    s_add_u32 s52, s52, 0x69000
    s_lshl_b32 s53, s45, 9
    s_add_u32 s53, s53, 0x7000
    v_mul_u32_u24 v75, s53, v71
    s_mov_b64 exec, 3
    buffer_load_dword v191, v75, s[28:31], s52 offen sc1
    s_mov_b64 exec, -1
    s_mov_b32 s26, 524288
    s_mov_b32 s27, 0x20000
    s_mov_b32 s34, 2097152
    s_mov_b32 s35, 0x20000
    s_mov_b32 s59, 0xffff0000
    s_getreg_b32 s47, hwreg(HW_REG_XCC_ID, 0, 4)
    s_mov_b32 s49, 200000
    s_mov_b32 s72, 0
    s_mov_b32 s65, 0x358637bd
    s_mov_b32 s84, 0x3fb8aa3b
    s_mov_b32 s85, 0x3fb8aa3b
    s_mov_b32 s100, 0x358637bd
    s_mov_b32 s101, 0x358637bd
    s_mov_b32 s67, 0x3727c5ac
    s_mov_b32 s68, 0x3b000000
    s_lshr_b32 s63, s45, 3
    s_and_b32 s64, s45, 7
    s_lshl_b32 s73, s46, 14
    s_lshl_b32 s87, s44, 3
    s_add_u32 s87, s87, s61
    v_mov_b32 v120, 0
    v_mov_b32 v121, 0
    v_mov_b32 v122, 0
    v_mov_b32 v123, 0
    s_cmp_lg_u32 s46, 0
    s_cbranch_scc1 L_zero_1
    v_lshrrev_b32 v75, 5, v0
    v_mul_u32_u24 v185, 4096, v75
    v_lshl_add_u32 v185, v0, 4, v185
    v_add_u32 v185, 0x21000, v185
    ds_write_b128 v185, v[120:123]
L_zero_1:
    s_cmp_lg_u32 s46, 1
    s_cbranch_scc1 L_zero_2
    v_bfe_u32 v75, v0, 1, 3
    v_mul_u32_u24 v185, 4160, v75
    v_and_b32_e64 v75, 1, v0
    v_lshl_add_u32 v185, v75, 4, v185
    v_add_u32 v185, 0x10000, v185
    ds_write_b128 v185, v[120:123]
L_zero_2:
    v_and_b32 v174, 31, v0
    v_lshrrev_b32 v75, 5, v0
    v_xor_b32 v75, v75, v174
    v_xor_b32 v75, 7, v75
    v_and_b32 v75, 7, v75
    v_lshlrev_b32 v75, 4, v75
    v_lshl_add_u32 v72, v174, 8, v75
    v_add_u32 v72, 0x1a000, v72
    v_lshlrev_b32 v73, 4, v0
    v_add_u32 v73, 0x1a000, v73
    v_lshrrev_b32 v174, 4, v0
    v_xor_b32 v174, v0, v174
    v_and_b32 v174, 7, v174
    v_lshrrev_b32 v175, 3, v0
    v_lshlrev_b32 v175, 12, v175
    v_lshl_add_u32 v174, v174, 4, v175
    s_lshl_b32 s53, s45, 7
    s_sub_u32 s52, 3968, s53
    v_add_u32 v74, s52, v174
    s_add_u32 s55, s51, 0x20000
    s_add_u32 s52, s63, 0
    s_and_b32 s52, s52, 3
    s_mul_i32 s88, s52, 98304
    s_lshl_b32 s92, s52, 14
    s_lshl_b32 s52, s52, 12
    s_add_u32 s96, s52, s73
    s_add_u32 s52, s63, 1
    s_and_b32 s52, s52, 3
    s_mul_i32 s89, s52, 98304
    s_lshl_b32 s93, s52, 14
    s_lshl_b32 s52, s52, 12
    s_add_u32 s97, s52, s73
    s_add_u32 s52, s63, 2
    s_and_b32 s52, s52, 3
    s_mul_i32 s90, s52, 98304
    s_lshl_b32 s94, s52, 14
    s_lshl_b32 s52, s52, 12
    s_add_u32 s98, s52, s73
    s_add_u32 s52, s63, 3
    s_and_b32 s52, s52, 3
    s_mul_i32 s91, s52, 98304
    s_lshl_b32 s95, s52, 14
    s_lshl_b32 s52, s52, 12
    s_add_u32 s99, s52, s73
    v_lshlrev_b32 v1, 4, v71
    v_lshlrev_b32 v2, 3, v71
    s_mul_i32 s52, s46, 393216
    s_lshl_b32 s53, s64, 7
    s_add_u32 s52, s52, s53
    v_lshrrev_b32 v176, 3, v71
    v_and_b32 v177, 2, v176
    v_mul_u32_u24 v176, 0xc00, v176
    v_xor_b32 v177, v71, v177
    v_and_b32 v177, 7, v177
    v_lshl_add_u32 v176, v177, 4, v176
    v_add_u32 v12, s52, v176
    v_xor_b32 v188, 64, v12
    s_lshl2_add_u32 s52, s2, s46
    s_lshr_b32 s53, s52, 1
    s_mul_i32 s53, s53, 3072
    s_and_b32 s54, s52, 1
    s_lshl_b32 s54, s54, 9
    s_add_u32 s53, s53, s54
    s_lshl_b32 s52, s52, 9
    v_lshlrev_b32 v75, 4, v2
    s_mov_b64 exec, 15
    buffer_load_dword v191, v75, s[20:23], s53 offen
    s_mov_b64 exec, -1
    s_lshl2_add_u32 s52, s45, s46
    s_mul_i32 s53, s52, 768
    s_add_u32 s53, s53, 0x40000
    v_lshl_add_u32 v186, v2, 4, s53
    s_and_b32 s54, s45, 15
    s_lshl_b32 s54, s54, 7
    s_add_u32 s54, s54, 0x68000
    v_writelane_b32 v186, s54, 6
    s_add_u32 m0, s96, 0
    s_add_u32 s86, s88, 1024
    buffer_load_dwordx4 v12, s[20:23], s86 offen offset:0 lds
    v_cmp_eq_u32 vcc, 0, v0
    v_lshlrev_b32 v184, 4, v0
    v_add_u32 v184, 0x10020, v184
    s_waitcnt lgkmcnt(0)
    s_lshl_b32 s53, s60, 16
    s_and_b32 s54, s60, s59
    s_waitcnt vmcnt(26)
    v_lshlrev_b32 v144, 16, v102
    v_add_f32 v144, s53, v144
    v_cvt_pk_bf16_f32 v144, v144, v144
    v_bfi_b32 v144, s59, v102, v144
    v_cndmask_b32 v102, v102, v144, vcc
    ds_write_b128 v184, v[102:105] offset:12480
    s_waitcnt vmcnt(25)
    v_cndmask_b32_e64 v100, v100, 0, vcc
    v_cndmask_b32_e64 v101, v101, 0, vcc
    s_add_u32 s86, s88, 24576
    buffer_load_dwordx4 v188, s[20:23], s86 offen offset:1024 lds
    v_alignbit_b32 v120, v101, v100, 16
    v_alignbit_b32 v121, v102, v101, 16
    v_alignbit_b32 v122, v103, v102, 16
    v_alignbit_b32 v123, v104, v103, 16
    ds_write_b128 v184, v[120:123] offset:0
    v_alignbit_b32 v124, v102, v101, 16
    v_alignbit_b32 v125, v103, v102, 16
    v_alignbit_b32 v126, v104, v103, 16
    v_alignbit_b32 v127, v105, v104, 16
    ds_write_b128 v184, v[124:127] offset:8320
    v_mov_b32 v128, v101
    v_mov_b32 v129, v102
    v_mov_b32 v130, v103
    s_add_u32 s86, s88, 48128
    buffer_load_dwordx4 v12, s[20:23], s86 offen offset:2048 lds
    v_mov_b32 v131, v104
    ds_write_b128 v184, v[128:131] offset:4160
    s_waitcnt vmcnt(26)
    v_lshlrev_b32 v144, 16, v108
    v_add_f32 v144, s54, v144
    v_cvt_pk_bf16_f32 v144, v144, v144
    v_bfi_b32 v144, s59, v108, v144
    v_cndmask_b32 v108, v108, v144, vcc
    ds_write_b128 v184, v[108:111] offset:29120
    s_waitcnt vmcnt(25)
    v_cndmask_b32_e64 v106, v106, 0, vcc
    v_cndmask_b32_e64 v107, v107, 0, vcc
    v_alignbit_b32 v132, v107, v106, 16
    v_alignbit_b32 v133, v108, v107, 16
    s_add_u32 s86, s88, 71680
    buffer_load_dwordx4 v188, s[20:23], s86 offen offset:3072 lds
    v_alignbit_b32 v134, v109, v108, 16
    v_alignbit_b32 v135, v110, v109, 16
    ds_write_b128 v184, v[132:135] offset:16640
    v_alignbit_b32 v136, v108, v107, 16
    v_alignbit_b32 v137, v109, v108, 16
    v_alignbit_b32 v138, v110, v109, 16
    v_alignbit_b32 v139, v111, v110, 16
    ds_write_b128 v184, v[136:139] offset:24960
    v_mov_b32 v140, v107
    v_mov_b32 v141, v108
    v_mov_b32 v142, v109
    v_mov_b32 v143, v110
    ds_write_b128 v184, v[140:143] offset:20800
    s_waitcnt vmcnt(25)
    v_lshlrev_b32 v142, 16, v96
    v_lshlrev_b32 v143, 16, v98
    v_and_b32 v144, s59, v96
    v_and_b32 v145, s59, v98
    v_lshlrev_b32 v146, 16, v97
    v_lshlrev_b32 v147, 16, v99
    v_and_b32 v148, s59, v97
    v_and_b32 v149, s59, v99
    s_waitcnt vmcnt(14)
    v_lshlrev_b32 v120, 16, v76
    v_and_b32 v121, s59, v76
    v_lshlrev_b32 v122, 16, v77
    v_and_b32 v123, s59, v77
    v_lshlrev_b32 v124, 16, v78
    v_and_b32 v125, s59, v78
    v_lshlrev_b32 v126, 16, v79
    v_and_b32 v127, s59, v79
    v_lshlrev_b32 v128, 16, v80
    v_and_b32 v129, s59, v80
    v_lshlrev_b32 v130, 16, v81
    v_and_b32 v131, s59, v81
    v_lshlrev_b32 v132, 16, v82
    v_and_b32 v133, s59, v82
    v_lshlrev_b32 v134, 16, v83
    v_and_b32 v135, s59, v83
    v_lshlrev_b32 v136, 16, v84
    v_and_b32 v137, s59, v84
    v_lshlrev_b32 v138, 16, v85
    v_and_b32 v139, s59, v85
    v_lshlrev_b32 v140, 16, v86
    v_and_b32 v141, s59, v86
    v_pk_mul_f32 v[150:151], v[120:121], v[148:149]
    v_pk_mul_f32 v[152:153], v[122:123], v[148:149]
    v_pk_mul_f32 v[154:155], v[124:125], v[148:149]
    v_pk_mul_f32 v[156:157], v[126:127], v[148:149]
    v_pk_mul_f32 v[158:159], v[128:129], v[148:149]
    v_pk_mul_f32 v[160:161], v[130:131], v[148:149]
    v_pk_mul_f32 v[162:163], v[132:133], v[148:149]
    v_pk_mul_f32 v[164:165], v[134:135], v[148:149]
    s_mov_b32 s53, 0x3f803f80
    v_pk_mul_f32 v[34:35], v[122:123], v[146:147]
    v_pk_mul_f32 v[36:37], v[124:125], v[146:147]
    v_pk_mul_f32 v[38:39], v[126:127], v[146:147]
    v_pk_mul_f32 v[40:41], v[128:129], v[146:147]
    v_pk_mul_f32 v[42:43], v[130:131], v[146:147]
    v_pk_mul_f32 v[44:45], v[132:133], v[146:147]
    v_pk_mul_f32 v[46:47], v[134:135], v[146:147]
    v_pk_mul_f32 v[48:49], v[136:137], v[146:147]
    v_cvt_pk_bf16_f32 v34, v150, v34
    v_cvt_pk_bf16_f32 v35, v151, v35
    v_cvt_pk_bf16_f32 v36, v152, v36
    v_cvt_pk_bf16_f32 v37, v153, v37
    v_cvt_pk_bf16_f32 v38, v154, v38
    v_cvt_pk_bf16_f32 v39, v155, v39
    v_cvt_pk_bf16_f32 v40, v156, v40
    v_cvt_pk_bf16_f32 v41, v157, v41
    v_cvt_pk_bf16_f32 v42, v158, v42
    v_cvt_pk_bf16_f32 v43, v159, v43
    v_cvt_pk_bf16_f32 v44, v160, v44
    v_cvt_pk_bf16_f32 v45, v161, v45
    v_cvt_pk_bf16_f32 v46, v162, v46
    v_cvt_pk_bf16_f32 v47, v163, v47
    v_cvt_pk_bf16_f32 v48, v164, v48
    v_cvt_pk_bf16_f32 v49, v165, v49
    v_dot2_f32_bf16 v150, v34, s53, 0
    v_dot2_f32_bf16 v151, v35, s53, 0
    v_dot2_f32_bf16 v152, v36, s53, 0
    v_dot2_f32_bf16 v153, v37, s53, 0
    v_dot2_f32_bf16 v154, v38, s53, 0
    v_dot2_f32_bf16 v155, v39, s53, 0
    v_dot2_f32_bf16 v156, v40, s53, 0
    v_dot2_f32_bf16 v157, v41, s53, 0
    v_dot2_f32_bf16 v158, v42, s53, 0
    v_dot2_f32_bf16 v159, v43, s53, 0
    v_dot2_f32_bf16 v160, v44, s53, 0
    v_dot2_f32_bf16 v161, v45, s53, 0
    v_dot2_f32_bf16 v162, v46, s53, 0
    v_dot2_f32_bf16 v163, v47, s53, 0
    v_dot2_f32_bf16 v164, v48, s53, 0
    v_dot2_f32_bf16 v165, v49, s53, 0
    v_pk_mul_f32 v[34:35], v[124:125], v[144:145]
    v_pk_mul_f32 v[36:37], v[126:127], v[144:145]
    v_pk_mul_f32 v[38:39], v[128:129], v[144:145]
    v_pk_mul_f32 v[40:41], v[130:131], v[144:145]
    v_pk_mul_f32 v[42:43], v[132:133], v[144:145]
    v_pk_mul_f32 v[44:45], v[134:135], v[144:145]
    v_pk_mul_f32 v[46:47], v[136:137], v[144:145]
    v_pk_mul_f32 v[48:49], v[138:139], v[144:145]
    v_cvt_pk_bf16_f32 v34, v150, v34
    v_cvt_pk_bf16_f32 v35, v151, v35
    v_cvt_pk_bf16_f32 v36, v152, v36
    v_cvt_pk_bf16_f32 v37, v153, v37
    v_cvt_pk_bf16_f32 v38, v154, v38
    v_cvt_pk_bf16_f32 v39, v155, v39
    v_cvt_pk_bf16_f32 v40, v156, v40
    v_cvt_pk_bf16_f32 v41, v157, v41
    v_cvt_pk_bf16_f32 v42, v158, v42
    v_cvt_pk_bf16_f32 v43, v159, v43
    v_cvt_pk_bf16_f32 v44, v160, v44
    v_cvt_pk_bf16_f32 v45, v161, v45
    v_cvt_pk_bf16_f32 v46, v162, v46
    v_cvt_pk_bf16_f32 v47, v163, v47
    v_cvt_pk_bf16_f32 v48, v164, v48
    v_cvt_pk_bf16_f32 v49, v165, v49
    v_dot2_f32_bf16 v150, v34, s53, 0
    v_dot2_f32_bf16 v151, v35, s53, 0
    v_dot2_f32_bf16 v152, v36, s53, 0
    v_dot2_f32_bf16 v153, v37, s53, 0
    v_dot2_f32_bf16 v154, v38, s53, 0
    v_dot2_f32_bf16 v155, v39, s53, 0
    v_dot2_f32_bf16 v156, v40, s53, 0
    v_dot2_f32_bf16 v157, v41, s53, 0
    v_dot2_f32_bf16 v158, v42, s53, 0
    v_dot2_f32_bf16 v159, v43, s53, 0
    v_dot2_f32_bf16 v160, v44, s53, 0
    v_dot2_f32_bf16 v161, v45, s53, 0
    v_dot2_f32_bf16 v162, v46, s53, 0
    v_dot2_f32_bf16 v163, v47, s53, 0
    v_dot2_f32_bf16 v164, v48, s53, 0
    v_dot2_f32_bf16 v165, v49, s53, 0
    v_pk_mul_f32 v[34:35], v[126:127], v[142:143]
    v_pk_mul_f32 v[36:37], v[128:129], v[142:143]
    v_pk_mul_f32 v[38:39], v[130:131], v[142:143]
    v_pk_mul_f32 v[40:41], v[132:133], v[142:143]
    v_pk_mul_f32 v[42:43], v[134:135], v[142:143]
    v_pk_mul_f32 v[44:45], v[136:137], v[142:143]
    v_pk_mul_f32 v[46:47], v[138:139], v[142:143]
    v_pk_mul_f32 v[48:49], v[140:141], v[142:143]
    v_cvt_pk_bf16_f32 v34, v150, v34
    v_cvt_pk_bf16_f32 v35, v151, v35
    v_cvt_pk_bf16_f32 v36, v152, v36
    v_cvt_pk_bf16_f32 v37, v153, v37
    v_cvt_pk_bf16_f32 v38, v154, v38
    v_cvt_pk_bf16_f32 v39, v155, v39
    v_cvt_pk_bf16_f32 v40, v156, v40
    v_cvt_pk_bf16_f32 v41, v157, v41
    v_cvt_pk_bf16_f32 v42, v158, v42
    v_cvt_pk_bf16_f32 v43, v159, v43
    v_cvt_pk_bf16_f32 v44, v160, v44
    v_cvt_pk_bf16_f32 v45, v161, v45
    v_cvt_pk_bf16_f32 v46, v162, v46
    v_cvt_pk_bf16_f32 v47, v163, v47
    v_cvt_pk_bf16_f32 v48, v164, v48
    v_cvt_pk_bf16_f32 v49, v165, v49
    v_dot2_f32_bf16 v150, v34, s53, 0
    v_dot2_f32_bf16 v151, v35, s53, 0
    v_dot2_f32_bf16 v152, v36, s53, 0
    v_dot2_f32_bf16 v153, v37, s53, 0
    v_dot2_f32_bf16 v154, v38, s53, 0
    v_dot2_f32_bf16 v155, v39, s53, 0
    v_dot2_f32_bf16 v156, v40, s53, 0
    v_dot2_f32_bf16 v157, v41, s53, 0
    v_dot2_f32_bf16 v158, v42, s53, 0
    v_dot2_f32_bf16 v159, v43, s53, 0
    v_dot2_f32_bf16 v160, v44, s53, 0
    v_dot2_f32_bf16 v161, v45, s53, 0
    v_dot2_f32_bf16 v162, v46, s53, 0
    v_dot2_f32_bf16 v163, v47, s53, 0
    v_dot2_f32_bf16 v164, v48, s53, 0
    v_dot2_f32_bf16 v165, v49, s53, 0
    s_waitcnt vmcnt(6)
    v_and_b32 v120, 0xffff, v88
    v_and_b32 v121, s59, v88
    v_and_b32 v122, 0xffff, v89
    v_and_b32 v123, s59, v89
    v_and_b32 v124, 0xffff, v90
    v_and_b32 v125, s59, v90
    v_and_b32 v126, 0xffff, v91
    v_and_b32 v127, s59, v91
    v_and_b32 v128, 0xffff, v92
    v_and_b32 v129, s59, v92
    v_and_b32 v130, 0xffff, v93
    v_and_b32 v131, s59, v93
    v_and_b32 v132, 0xffff, v94
    v_and_b32 v133, s59, v94
    v_and_b32 v134, 0xffff, v95
    v_and_b32_e64 v135, s59, v95
    v_cvt_pk_bf16_f32 v34, v150, v151
    v_cvt_pk_bf16_f32 v35, v152, v153
    v_cvt_pk_bf16_f32 v36, v154, v155
    v_cvt_pk_bf16_f32 v37, v156, v157
    v_cvt_pk_bf16_f32 v38, v158, v159
    v_cvt_pk_bf16_f32 v39, v160, v161
    v_cvt_pk_bf16_f32 v40, v162, v163
    v_cvt_pk_bf16_f32 v41, v164, v165
    v_dot2_f32_bf16 v150, v34, v120, 0
    v_dot2_f32_bf16 v151, v34, v121, 0
    v_dot2_f32_bf16 v152, v35, v122, 0
    v_dot2_f32_bf16 v153, v35, v123, 0
    v_dot2_f32_bf16 v154, v36, v124, 0
    v_dot2_f32_bf16 v155, v36, v125, 0
    v_dot2_f32_bf16 v156, v37, v126, 0
    v_dot2_f32_bf16 v157, v37, v127, 0
    v_dot2_f32_bf16 v158, v38, v128, 0
    v_dot2_f32_bf16 v159, v38, v129, 0
    v_dot2_f32_bf16 v160, v39, v130, 0
    v_dot2_f32_bf16 v161, v39, v131, 0
    v_dot2_f32_bf16 v162, v40, v132, 0
    v_dot2_f32_bf16 v163, v40, v133, 0
    v_dot2_f32_bf16 v164, v41, v134, 0
    v_dot2_f32_bf16 v165, v41, v135, 0
    s_nop 1
    v_cvt_pk_bf16_f32 v166, v164, v162
    v_cvt_pk_bf16_f32 v167, v160, v158
    v_cvt_pk_bf16_f32 v168, v156, v154
    v_cvt_pk_bf16_f32 v169, v152, v150
    ds_write_b128 v72, v[166:169] offset:0
    v_cvt_pk_bf16_f32 v170, v165, v163
    v_cvt_pk_bf16_f32 v171, v161, v159
    v_cvt_pk_bf16_f32 v172, v157, v155
    v_cvt_pk_bf16_f32 v173, v153, v151
    ds_write_b128 v72, v[170:173] offset:128
    s_waitcnt lgkmcnt(0)
    s_barrier
    ds_read_b128 v[166:169], v73 offset:0
    ds_read_b128 v[170:173], v73 offset:4096
    s_waitcnt lgkmcnt(1)
    buffer_store_dwordx4 v[166:169], v74, s[28:31], s51 offen sc1
    s_waitcnt lgkmcnt(0)
    buffer_store_dwordx4 v[170:173], v74, s[28:31], s55 offen sc1
    s_add_u32 m0, s97, 0
    s_add_u32 s86, s89, 1024
    buffer_load_dwordx4 v12, s[20:23], s86 offen offset:0 lds
    s_lshr_b32 s52, s46, 1
    s_mul_i32 s52, s52, 16640
    s_and_b32 s53, s46, 1
    s_lshl_b32 s53, s53, 8
    s_add_u32 s52, s52, s53
    s_add_u32 s52, s52, 0x10008
    v_and_b32 v75, 3, v71
    v_mul_u32_u24 v184, 4160, v75
    v_and_b32 v75, 12, v71
    v_lshl_add_u32 v184, v75, 1, v184
    v_and_b32_e64 v75, 48, v71
    v_add3_u32 v184, v184, v75, s52
    ds_read_b64 a[128:129], v184 offset:0
    ds_read_b64 a[130:131], v184 offset:8
    ds_read_b64 a[132:133], v184 offset:512
    ds_read_b64 a[134:135], v184 offset:520
    ds_read_b64 a[136:137], v184 offset:1024
    ds_read_b64 a[138:139], v184 offset:1032
    ds_read_b64 a[140:141], v184 offset:1536
    s_add_u32 s86, s89, 24576
    buffer_load_dwordx4 v188, s[20:23], s86 offen offset:1024 lds
    ds_read_b64 a[142:143], v184 offset:1544
    ds_read_b64 a[144:145], v184 offset:2048
    ds_read_b64 a[146:147], v184 offset:2056
    ds_read_b64 a[148:149], v184 offset:2560
    ds_read_b64 a[150:151], v184 offset:2568
    ds_read_b64 a[152:153], v184 offset:3072
    ds_read_b64 a[154:155], v184 offset:3080
    ds_read_b64 a[156:157], v184 offset:3584
    ds_read_b64 a[158:159], v184 offset:3592
    ds_read_b64 a[160:161], v184 offset:64
    ds_read_b64 a[162:163], v184 offset:72
    ds_read_b64 a[164:165], v184 offset:576
    ds_read_b64 a[166:167], v184 offset:584
    ds_read_b64 a[168:169], v184 offset:1088
    ds_read_b64 a[170:171], v184 offset:1096
    ds_read_b64 a[172:173], v184 offset:1600
    ds_read_b64 a[174:175], v184 offset:1608
    ds_read_b64 a[176:177], v184 offset:2112
    ds_read_b64 a[178:179], v184 offset:2120
    s_add_u32 s86, s89, 48128
    buffer_load_dwordx4 v12, s[20:23], s86 offen offset:2048 lds
    ds_read_b64 a[180:181], v184 offset:2624
    ds_read_b64 a[182:183], v184 offset:2632
    ds_read_b64 a[184:185], v184 offset:3136
    ds_read_b64 a[186:187], v184 offset:3144
    ds_read_b64 a[188:189], v184 offset:3648
    ds_read_b64 a[190:191], v184 offset:3656
    ds_read_b64 a[192:193], v184 offset:128
    ds_read_b64 a[194:195], v184 offset:136
    ds_read_b64 a[196:197], v184 offset:640
    ds_read_b64 a[198:199], v184 offset:648
    ds_read_b64 a[200:201], v184 offset:1152
    ds_read_b64 a[202:203], v184 offset:1160
    ds_read_b64 a[204:205], v184 offset:1664
    ds_read_b64 a[206:207], v184 offset:1672
    ds_read_b64 a[208:209], v184 offset:2176
    ds_read_b64 a[210:211], v184 offset:2184
    ds_read_b64 a[212:213], v184 offset:2688
    ds_read_b64 a[214:215], v184 offset:2696
    ds_read_b64 a[216:217], v184 offset:3200
    s_add_u32 s86, s89, 71680
    buffer_load_dwordx4 v188, s[20:23], s86 offen offset:3072 lds
    ds_read_b64 a[218:219], v184 offset:3208
    ds_read_b64 a[220:221], v184 offset:3712
    ds_read_b64 a[222:223], v184 offset:3720
    ds_read_b64 a[224:225], v184 offset:192
    ds_read_b64 a[226:227], v184 offset:200
    ds_read_b64 a[228:229], v184 offset:704
    ds_read_b64 a[230:231], v184 offset:712
    ds_read_b64 a[232:233], v184 offset:1216
    ds_read_b64 a[234:235], v184 offset:1224
    ds_read_b64 a[236:237], v184 offset:1728
    ds_read_b64 a[238:239], v184 offset:1736
    ds_read_b64 a[240:241], v184 offset:2240
    ds_read_b64 a[242:243], v184 offset:2248
    ds_read_b64 a[244:245], v184 offset:2752
    ds_read_b64 a[246:247], v184 offset:2760
    ds_read_b64 a[248:249], v184 offset:3264
    ds_read_b64 a[250:251], v184 offset:3272
    ds_read_b64 a[252:253], v184 offset:3776
    ds_read_b64 a[254:255], v184 offset:3784
    s_add_u32 s42, s42, 16
    s_addc_u32 s43, s43, 0
    v_mov_b32 v18, s42
    v_mov_b32 v19, s43
    s_add_u32 s56, s42, s47
    s_addc_u32 s57, s43, 0
    v_mov_b32 v174, s56
    v_mov_b32 v175, s57
    s_lshl_b32 s52, s45, 3
    s_add_u32 s52, s52, s51
    s_add_u32 s52, s52, 0x69000
    s_waitcnt vmcnt(4)
    s_barrier
    s_cmp_lg_u32 s46, 0
    s_cbranch_scc1 L_fa_3
    s_mov_b64 exec, 1
    buffer_store_dwordx2 v[174:175], off, s[28:31], s52
    s_mov_b64 exec, -1
L_fa_3:
    s_add_u32 m0, s98, 0
    s_add_u32 s86, s90, 1024
    buffer_load_dwordx4 v12, s[20:23], s86 offen offset:0 lds
    s_lshl_b32 s52, s44, 18
    s_lshl_b32 s53, s61, 15
    s_add_u32 s52, s52, s53
    s_lshl_b32 s53, s62, 6
    s_add_u32 s52, s52, s53
    v_and_b32 v75, 7, v71
    v_lshlrev_b32 v3, 12, v75
    v_bfe_u32 v75, v71, 3, 1
    v_lshl_add_u32 v3, v75, 11, v3
    v_bfe_u32 v75, v71, 4, 1
    v_lshl_add_u32 v3, v75, 10, v3
    v_and_b32 v75, 32, v71
    v_add3_u32 v3, v3, v75, s52
    v_mov_b32 v62, -1
    s_add_u32 s86, s90, 24576
    buffer_load_dwordx4 v188, s[20:23], s86 offen offset:1024 lds
    v_mov_b32 v63, -1
    v_mov_b32 v64, -1
    v_mov_b32 v65, -1
    s_lshl2_add_u32 s74, s45, s46
    s_lshl2_add_u32 s75, s63, s46
    v_bfe_u32 v58, v1, 7, 2
    v_xor_b32 v58, s46, v58
    v_and_b32_e64 v59, 24, v2
    v_lshl_add_u32 v58, v58, 5, v59
    v_and_b32 v59, 0xc0, v1
    v_lshl_add_u32 v58, v59, 1, v58
    v_and_b32 v59, 0x300, v1
    v_lshl_add_u32 v10, v59, 2, v58
    s_lshl_b32 s76, s44, 19
    s_add_u32 s86, s90, 48128
    buffer_load_dwordx4 v12, s[20:23], s86 offen offset:2048 lds
    s_lshl_b32 s9, s74, 12
    s_add_u32 s76, s76, s9
    v_and_b32 v58, 0xf0, v1
    v_lshl_add_u32 v59, v59, 2, v58
    v_add_u32 v4, s76, v59
    s_lshr_b32 s60, s75, 1
    s_lshl_b32 s76, s75, 9
    s_and_b32 s11, s46, 1
    v_lshrrev_b32 v59, 8, v1
    v_lshl_add_u32 v59, v59, 3, s76
    v_lshl_add_u32 v189, v58, 1, v59
    s_lshl_b32 s60, s60, 7
    s_add_u32 s76, s51, 0x68000
    s_add_u32 s60, s60, s76
    s_add_u32 s86, s90, 71680
    buffer_load_dwordx4 v188, s[20:23], s86 offen offset:3072 lds
    s_lshl3_add_u32 s3, s74, s76
    s_lshl_b32 s83, s75, 14
    s_add_u32 s83, s83, s51
    s_lshl_b32 s76, s61, 15
    s_lshl_b32 s8, s62, 10
    s_add_u32 s76, s76, s8
    v_and_b32 v59, 0x2f0, v1
    v_add_u32 v7, s76, v59
    v_and_b32 v59, 0x100, v1
    v_lshl_add_u32 v7, v59, 6, v7
    v_lshrrev_b32 v58, 2, v58
    v_add_u32 v15, 0x22400, v58
    s_lshl_b32 s76, s46, 6
    v_add3_u32 v17, v15, v59, s76
    v_and_b32 v58, 48, v71
    s_add_u32 s52, s51, 0x69000
    v_and_b32 v124, 0xff, v2
    s_lshl_b32 s55, s45, 13
    s_add_u32 s55, s55, s51
    s_lshl_b32 s53, s46, 11
    s_add_u32 s55, s55, s53
    s_lshr_b32 s54, s46, 1
    s_lshl_b32 s54, s54, 9
    s_add_u32 s53, s53, s54
    s_add_u32 m0, s53, 131072
    s_mov_b32 s50, 48
    s_mov_b32 s48, 1
L_h1_4:
    buffer_load_dwordx2 v[120:121], v124, s[28:31], s52 offen sc1
    s_waitcnt vmcnt(0)
    v_cmp_ne_u64 vcc, s[56:57], v[120:121]
    s_nop 0
    s_cbranch_vccz L_h1got_6
    s_sub_u32 s50, s50, 1
    s_cbranch_scc0 L_h1_4
    s_branch L_h1slow_7
L_h1got_6:
    buffer_load_dwordx4 v1, s[28:31], s55 offen sc1 lds
    buffer_load_dwordx4 v1, s[28:31], s55 offen offset:1024 sc1 lds
    s_lshl2_add_u32 s79, s45, s46
    s_mul_i32 s78, s79, 768
    s_add_u32 s78, s78, s51
    s_add_u32 s78, s78, 0x40000
    s_cmp_eq_u32 s48, 0
    s_cbranch_scc1 L_slowst_9
    s_mov_b32 exec_hi, 0xffff
    buffer_store_dwordx4 v[62:65], v1, s[28:31], s78 offen
    s_mov_b64 exec, -1
L_joinst_10:
    s_lshl2_add_u32 s52, s2, s46
    s_lshl_b32 s53, s52, 10
    s_add_u32 s53, s53, 0x80000
    s_lshl_b32 s54, s52, 7
    s_add_u32 s54, s54, 0x180000
    buffer_store_dwordx4 v[62:65], v1, s[28:31], s53 offen sc1
    s_mov_b64 exec, 0xff
    buffer_store_dwordx4 v[62:65], v1, s[28:31], s54 offen sc1
    s_mov_b64 exec, -1
    s_add_u32 m0, s99, 0
    s_add_u32 s86, s91, 1024
    buffer_load_dwordx4 v12, s[20:23], s86 offen offset:0 lds
    s_add_u32 s86, s91, 24576
    buffer_load_dwordx4 v188, s[20:23], s86 offen offset:1024 lds
    s_add_u32 s86, s91, 48128
    buffer_load_dwordx4 v12, s[20:23], s86 offen offset:2048 lds
    s_add_u32 s86, s91, 71680
    buffer_load_dwordx4 v188, s[20:23], s86 offen offset:3072 lds
    buffer_load_dwordx4 v[50:53], v3, s[4:7], 0 offen
    buffer_load_dwordx4 v[54:57], v3, s[4:7], 0 offen offset:16
    s_lshr_b32 s52, s46, 1
    s_mul_i32 s52, s52, 4608
    s_and_b32 s53, s46, 1
    s_lshl_b32 s53, s53, 8
    s_add_u32 s52, s52, s53
    s_add_u32 s52, s52, 0x201e0
    v_and_b32 v75, 15, v71
    v_lshlrev_b32 v72, 5, v75
    v_sub_u32 v72, s52, v72
    v_lshrrev_b32 v74, 1, v75
    v_lshlrev_b32 v74, 16, v74
    v_and_b32 v75, 1, v71
    v_lshl_add_u32 v74, v75, 6, v74
    v_and_b32 v75, 48, v71
    v_add_u32 v72, v72, v75
    v_add_u32 v74, v75, v74
    s_lshl_b32 s52, s44, 5
    s_add_u32 s52, s52, s45
    s_lshl_b32 s52, s52, 8
    v_add_u32 v74, s52, v74
    s_or_b32 s69, s42, 0x80000000
    s_and_b32 s69, s69, -2
    v_mov_b32 v101, s69
    v_mov_b32 v103, s69
    v_mov_b32 v105, s69
    v_mov_b32 v107, s69
    v_mov_b32 v175, s69
    s_lshl_b32 s52, s61, 11
    s_add_u32 s52, s52, 0x70000
    v_and_b32 v75, 0x1f0, v1
    v_add_u32 v75, s52, v75
    v_lshrrev_b32 v176, 5, v71
    v_lshl_add_u32 v177, v176, 10, v75
    v_lshl_add_u32 v176, v176, 3, v75
    s_and_b32 s52, s45, 3
    s_lshl_b32 s52, s52, 9
    v_add_u32 v176, s52, v176
    v_lshrrev_b32 v173, 2, v1
    v_add_u32 v173, 0x26400, v173
    s_lshl_b32 s52, s46, 10
    s_add_u32 s52, s52, 0x22400
    v_add_u32 v172, s52, v1
    s_lshr_b32 s52, s46, 1
    s_lshl_b32 s58, s52, 19
    s_lshl_b32 s52, s52, 12
    s_and_b32 s53, s46, 1
    s_lshl_b32 s54, s53, 7
    s_add_u32 s58, s58, s54
    s_add_u32 s58, s58, 0x200000
    s_lshl_b32 s53, s53, 3
    s_add_u32 s52, s52, s53
    s_add_u32 s52, s52, 0x22400
    v_add_u32 v73, s52, v1
    s_waitcnt vmcnt(9)
    s_waitcnt lgkmcnt(0)
    s_barrier
    ds_read_b128 v[192:195], v72 offset:3584
    ds_read_b128 v[196:199], v72 offset:3648
    ds_read_b128 v[200:203], v72 offset:3712
    ds_read_b128 v[204:207], v72 offset:3776
    ds_read_b128 v[208:211], v72 offset:3072
    ds_read_b128 v[212:215], v72 offset:3136
    ds_read_b128 v[216:219], v72 offset:3200
    ds_read_b128 v[220:223], v72 offset:3264
    s_add_u32 s40, s58, 3145728
    buffer_store_dwordx4 v[62:65], v74, s[28:31], s40 offen sc1
    s_waitcnt lgkmcnt(7)
    v_mfma_f32_16x16x32_bf16 v[76:79], a[128:131], v[192:195], 0
    ds_read_b128 v[224:227], v72 offset:2560
    s_add_u32 m0, s96, 65536
    s_waitcnt lgkmcnt(7)
    v_mfma_f32_16x16x32_bf16 v[76:79], a[160:163], v[196:199], v[76:79]
    ds_read_b128 v[228:231], v72 offset:2624
    s_add_u32 s86, s88, 2048
    s_waitcnt lgkmcnt(7)
    v_mfma_f32_16x16x32_bf16 v[76:79], a[192:195], v[200:203], v[76:79]
    ds_read_b128 v[232:235], v72 offset:2688
    v_add_u32 v14, 0x22400, v58
    s_waitcnt lgkmcnt(7)
    v_mfma_f32_16x16x32_bf16 v[76:79], a[224:227], v[204:207], v[76:79]
    ds_read_b128 v[236:239], v72 offset:2752
    s_lshr_b32 s76, s74, 1
    s_waitcnt lgkmcnt(7)
    v_mfma_f32_16x16x32_bf16 v[80:83], a[128:131], v[208:211], 0
    ds_read_b128 v[240:243], v72 offset:2048
    s_lshl_b32 s76, s76, 9
    v_mfma_f32_16x16x32_bf16 v[80:83], a[132:135], v[192:195], v[80:83]
    ds_read_b128 v[244:247], v72 offset:2112
    s_lshl3_add_u32 s11, s11, s76
    s_waitcnt lgkmcnt(8)
    v_mfma_f32_16x16x32_bf16 v[80:83], a[160:163], v[212:215], v[80:83]
    ds_read_b128 v[248:251], v72 offset:2176
    s_lshl_b32 s76, s61, 10
    v_mfma_f32_16x16x32_bf16 v[80:83], a[164:167], v[196:199], v[80:83]
    ds_write_b128 v172, v[76:79] offset:0
    s_waitcnt lgkmcnt(9)
    v_mfma_f32_16x16x32_bf16 v[80:83], a[192:195], v[216:219], v[80:83]
    ds_read_b128 v[252:255], v72 offset:2240
    v_and_b32 v58, 0x1f0, v1
    v_mfma_f32_16x16x32_bf16 v[80:83], a[196:199], v[200:203], v[80:83]
    ds_read_b128 v[108:111], v72 offset:1536
    v_lshl_add_u32 v58, v58, 1, s76
    s_waitcnt lgkmcnt(10)
    v_mfma_f32_16x16x32_bf16 v[80:83], a[224:227], v[220:223], v[80:83]
    ds_read_b128 v[112:115], v72 offset:1600
    v_lshrrev_b32 v59, 9, v1
    v_mfma_f32_16x16x32_bf16 v[80:83], a[228:231], v[204:207], v[80:83]
    ds_read_b128 v[116:119], v72 offset:1664
    s_waitcnt lgkmcnt(3)
    v_mfma_f32_16x16x32_bf16 v[84:87], a[128:131], v[224:227], 0
    ds_read_b128 v[120:123], v72 offset:1728
    v_lshl_add_u32 v6, v59, 4, v58
    v_mfma_f32_16x16x32_bf16 v[84:87], a[132:135], v[208:211], v[84:87]
    ds_read_b128 v[124:127], v72 offset:1024
    s_and_b32 s76, s45, 3
    v_mfma_f32_16x16x32_bf16 v[84:87], a[136:139], v[192:195], v[84:87]
    ds_read_b128 v[128:131], v72 offset:1088
    s_lshl_b32 s76, s76, 3
    v_mfma_f32_16x16x32_bf16 v[84:87], a[160:163], v[228:231], v[84:87]
    ds_write_b128 v172, v[80:83] offset:4096
    v_mfma_f32_16x16x32_bf16 v[84:87], a[164:167], v[212:215], v[84:87]
    ds_read_b128 v[132:135], v72 offset:1152
    v_lshl_add_u32 v58, v59, 2, v58
    v_mfma_f32_16x16x32_bf16 v[84:87], a[168:171], v[196:199], v[84:87]
    ds_read_b128 v[136:139], v72 offset:1216
    v_add_u32_e64 v5, s76, v58
    v_mfma_f32_16x16x32_bf16 v[84:87], a[192:195], v[232:235], v[84:87]
    ds_read_b128 v[140:143], v72 offset:512
    v_mov_b32 v24, 0x3f803f80
    v_mfma_f32_16x16x32_bf16 v[84:87], a[196:199], v[216:219], v[84:87]
    ds_read_b128 v[144:147], v72 offset:576
    s_waitcnt lgkmcnt(4)
    s_barrier
    v_mfma_f32_16x16x32_bf16 v[84:87], a[200:203], v[200:203], v[84:87]
    ds_read_b128 v[148:151], v72 offset:640
    ds_read_b64 v[92:93], v73 offset:0
    v_mfma_f32_16x16x32_bf16 v[84:87], a[224:227], v[236:239], v[84:87]
    ds_read_b128 v[152:155], v72 offset:704
    ds_read_b64 v[94:95], v73 offset:1024
    v_mfma_f32_16x16x32_bf16 v[84:87], a[228:231], v[220:223], v[84:87]
    ds_read_b128 v[156:159], v72 offset:0
    ds_read_b64 v[96:97], v73 offset:2048
    v_mfma_f32_16x16x32_bf16 v[84:87], a[232:235], v[204:207], v[84:87]
    ds_read_b128 v[160:163], v72 offset:64
    ds_read_b64 v[98:99], v73 offset:3072
    v_mfma_f32_16x16x32_bf16 v[88:91], a[128:131], v[240:243], 0
    ds_read_b128 v[164:167], v72 offset:128
    v_mov_b32 v25, 0x3f803f80
    v_mfma_f32_16x16x32_bf16 v[88:91], a[132:135], v[224:227], v[88:91]
    ds_read_b128 v[168:171], v72 offset:192
    v_mov_b32 v26, 0x3f803f80
    v_mfma_f32_16x16x32_bf16 v[88:91], a[136:139], v[208:211], v[88:91]
    buffer_load_dwordx4 v12, s[20:23], s86 offen offset:0 lds
    v_mfma_f32_16x16x32_bf16 v[88:91], a[140:143], v[192:195], v[88:91]
    ds_write_b128 v172, v[84:87] offset:8192
    v_mfma_f32_16x16x32_bf16 v[88:91], a[160:163], v[244:247], v[88:91]
    s_add_u32 s86, s88, 25600
    v_mov_b32 v27, 0x3f803f80
    v_mfma_f32_16x16x32_bf16 v[88:91], a[164:167], v[228:231], v[88:91]
    s_waitcnt lgkmcnt(7)
    v_add_f32 v92, v92, v94
    v_add_f32 v93, v93, v95
    v_mfma_f32_16x16x32_bf16 v[88:91], a[168:171], v[212:215], v[88:91]
    s_waitcnt lgkmcnt(3)
    v_add_f32 v96, v96, v98
    v_add_f32 v97, v97, v99
    v_mfma_f32_16x16x32_bf16 v[88:91], a[172:175], v[196:199], v[88:91]
    v_cvt_pk_bf16_f32 v100, v92, v96
    v_cvt_pk_bf16_f32 v102, v93, v97
    v_mfma_f32_16x16x32_bf16 v[88:91], a[192:195], v[248:251], v[88:91]
    buffer_load_dwordx4 v188, s[20:23], s86 offen offset:1024 lds
    v_mfma_f32_16x16x32_bf16 v[88:91], a[196:199], v[232:235], v[88:91]
    s_add_u32 s86, s88, 49152
    s_add_u32 s18, s51, 0x50000
    v_mfma_f32_16x16x32_bf16 v[88:91], a[200:203], v[216:219], v[88:91]
    s_mov_b32 s36, 0x200000
    s_mov_b32 s38, 0xffff0000
    v_mfma_f32_16x16x32_bf16 v[88:91], a[204:207], v[200:203], v[88:91]
    s_mov_b32 s39, 0xffff0000
    s_and_b32 s76, s45, 3
    v_mfma_f32_16x16x32_bf16 v[88:91], a[224:227], v[252:255], v[88:91]
    buffer_load_dwordx4 v12, s[20:23], s86 offen offset:2048 lds
    v_mfma_f32_16x16x32_bf16 v[88:91], a[228:231], v[236:239], v[88:91]
    s_add_u32 s86, s88, 72704
    s_lshl_b32 s76, s76, 8
    v_mfma_f32_16x16x32_bf16 v[88:91], a[232:235], v[220:223], v[88:91]
    s_lshl2_add_u32 s76, s73, s76
    v_lshrrev_b32 v58, 2, v1
    v_mfma_f32_16x16x32_bf16 v[88:91], a[236:239], v[204:207], v[88:91]
    v_xor_b32_e64 v58, v1, v58
    v_mfma_f32_16x16x32_bf16 v[76:79], a[128:131], v[108:111], 0
    buffer_load_dwordx4 v188, s[20:23], s86 offen offset:3072 lds
    v_mfma_f32_16x16x32_bf16 v[76:79], a[132:135], v[240:243], v[76:79]
    s_add_u32 m0, s97, 65536
    s_add_u32 s86, s89, 2048
    v_mfma_f32_16x16x32_bf16 v[76:79], a[136:139], v[224:227], v[76:79]
    v_and_b32 v58, 0xc0, v58
    v_and_b32_e64 v59, 0x30, v1
    v_mfma_f32_16x16x32_bf16 v[76:79], a[140:143], v[208:211], v[76:79]
    ds_write_b128 v172, v[88:91] offset:12288
    v_mfma_f32_16x16x32_bf16 v[76:79], a[144:147], v[192:195], v[76:79]
    v_add3_u32 v58, v58, v59, s76
    v_and_b32 v59, 0x300, v1
    v_mfma_f32_16x16x32_bf16 v[76:79], a[160:163], v[112:115], v[76:79]
    buffer_load_dwordx4 v12, s[20:23], s86 offen offset:0 lds
    v_mfma_f32_16x16x32_bf16 v[76:79], a[164:167], v[244:247], v[76:79]
    s_add_u32 s86, s89, 25600
    v_lshl_add_u32 v13, v59, 2, v58
    v_mfma_f32_16x16x32_bf16 v[76:79], a[168:171], v[228:231], v[76:79]
    s_waitcnt lgkmcnt(0)
    s_waitcnt vmcnt(14)
    s_waitcnt vmcnt(12)
    s_barrier
    v_mfma_f32_16x16x32_bf16 v[76:79], a[172:175], v[212:215], v[76:79]
    ds_read_b64 v[92:93], v73 offset:8192
    ds_read_b64 v[94:95], v73 offset:9216
    v_mfma_f32_16x16x32_bf16 v[76:79], a[176:179], v[196:199], v[76:79]
    ds_read_b64 v[96:97], v73 offset:10240
    ds_read_b64 v[98:99], v73 offset:11264
    v_mfma_f32_16x16x32_bf16 v[76:79], a[192:195], v[116:119], v[76:79]
    s_cmp_lg_u32 s46, 1
    s_cbranch_scc1 L_hello_11
    s_lshl_b32 s40, s45, 3
    s_add_u32 s40, s40, s51
    s_add_u32 s40, s40, 0x69100
    s_mov_b64 exec, 1
    s_cmp_eq_u32 s48, 0
    s_cbranch_scc1 L_slowst_12
    buffer_store_dwordx2 v[18:19], off, s[28:31], s40 offset:0
L_joinst_13:
    s_mov_b64 exec, -1
L_hello_11:
    v_mfma_f32_16x16x32_bf16 v[76:79], a[196:199], v[248:251], v[76:79]
    buffer_load_dwordx4 v188, s[20:23], s86 offen offset:1024 lds
    v_mfma_f32_16x16x32_bf16 v[76:79], a[200:203], v[232:235], v[76:79]
    s_add_u32 s86, s89, 49152
    v_mfma_f32_16x16x32_bf16 v[76:79], a[204:207], v[216:219], v[76:79]
    v_mfma_f32_16x16x32_bf16 v[76:79], a[208:211], v[200:203], v[76:79]
    v_mfma_f32_16x16x32_bf16 v[76:79], a[224:227], v[120:123], v[76:79]
    v_mfma_f32_16x16x32_bf16 v[76:79], a[228:231], v[252:255], v[76:79]
    buffer_load_dwordx4 v12, s[20:23], s86 offen offset:2048 lds
    v_mfma_f32_16x16x32_bf16 v[76:79], a[232:235], v[236:239], v[76:79]
    s_waitcnt lgkmcnt(2)
    v_add_f32 v92, v92, v94
    v_add_f32 v93, v93, v95
    v_mfma_f32_16x16x32_bf16 v[76:79], a[236:239], v[220:223], v[76:79]
    s_waitcnt lgkmcnt(0)
    v_add_f32 v96, v96, v98
    v_add_f32 v97, v97, v99
    v_mfma_f32_16x16x32_bf16 v[76:79], a[240:243], v[204:207], v[76:79]
    v_cvt_pk_bf16_f32 v104, v92, v96
    v_cvt_pk_bf16_f32 v106, v93, v97
    v_mfma_f32_16x16x32_bf16 v[80:83], a[128:131], v[124:127], 0
    s_add_u32 s86, s89, 72704
    v_mfma_f32_16x16x32_bf16 v[80:83], a[132:135], v[108:111], v[80:83]
    buffer_load_dwordx4 v188, s[20:23], s86 offen offset:3072 lds
    v_mfma_f32_16x16x32_bf16 v[80:83], a[136:139], v[240:243], v[80:83]
    s_add_u32 m0, s98, 65536
    s_add_u32 s86, s90, 2048
    v_mfma_f32_16x16x32_bf16 v[80:83], a[140:143], v[224:227], v[80:83]
    ds_write_b128 v172, v[76:79] offset:0
    v_mfma_f32_16x16x32_bf16 v[80:83], a[144:147], v[208:211], v[80:83]
    v_mfma_f32_16x16x32_bf16 v[80:83], a[148:151], v[192:195], v[80:83]
    v_mfma_f32_16x16x32_bf16 v[80:83], a[160:163], v[128:131], v[80:83]
    buffer_load_dwordx4 v12, s[20:23], s86 offen offset:0 lds
    v_mfma_f32_16x16x32_bf16 v[80:83], a[164:167], v[112:115], v[80:83]
    s_add_u32 s86, s90, 25600
    s_waitcnt vmcnt(11)
    v_lshlrev_b32 v34, 16, v50
    v_mfma_f32_16x16x32_bf16 v[80:83], a[168:171], v[244:247], v[80:83]
    v_and_b32 v35, s59, v50
    v_lshlrev_b32 v36, 16, v51
    v_mfma_f32_16x16x32_bf16 v[80:83], a[172:175], v[228:231], v[80:83]
    v_and_b32 v37, s59, v51
    v_lshlrev_b32 v38, 16, v52
    v_mfma_f32_16x16x32_bf16 v[80:83], a[176:179], v[212:215], v[80:83]
    v_and_b32 v39, s59, v52
    v_lshlrev_b32 v40, 16, v53
    v_mfma_f32_16x16x32_bf16 v[80:83], a[180:183], v[196:199], v[80:83]
    buffer_load_dwordx4 v188, s[20:23], s86 offen offset:1024 lds
    v_mfma_f32_16x16x32_bf16 v[80:83], a[192:195], v[132:135], v[80:83]
    s_add_u32 s86, s90, 49152
    v_and_b32 v41, s59, v53
    v_mfma_f32_16x16x32_bf16 v[80:83], a[196:199], v[116:119], v[80:83]
    s_waitcnt vmcnt(11)
    v_lshlrev_b32 v42, 16, v54
    v_and_b32 v43, s59, v54
    v_mfma_f32_16x16x32_bf16 v[80:83], a[200:203], v[248:251], v[80:83]
    v_lshlrev_b32 v44, 16, v55
    v_and_b32 v45, s59, v55
    v_mfma_f32_16x16x32_bf16 v[80:83], a[204:207], v[232:235], v[80:83]
    v_lshlrev_b32 v46, 16, v56
    v_and_b32 v47, s59, v56
    v_mfma_f32_16x16x32_bf16 v[80:83], a[208:211], v[216:219], v[80:83]
    buffer_load_dwordx4 v12, s[20:23], s86 offen offset:2048 lds
    v_mfma_f32_16x16x32_bf16 v[80:83], a[212:215], v[200:203], v[80:83]
    s_add_u32 s86, s90, 72704
    v_lshlrev_b32 v48, 16, v57
    v_mfma_f32_16x16x32_bf16 v[80:83], a[224:227], v[136:139], v[80:83]
    v_and_b32 v49, s59, v57
    v_mul_f32 v180, v34, v34
    v_mfma_f32_16x16x32_bf16 v[80:83], a[228:231], v[120:123], v[80:83]
    v_add_f32_e64 v178, v34, v35
    v_fmac_f32 v180, v35, v35
    v_mfma_f32_16x16x32_bf16 v[80:83], a[232:235], v[252:255], v[80:83]
    buffer_store_dwordx4 v[100:103], v74, s[28:31], s58 offen sc1
    v_mfma_f32_16x16x32_bf16 v[80:83], a[236:239], v[236:239], v[80:83]
    s_add_u32 s58, s58, 0x100000
    v_fmac_f32 v180, v36, v36
    v_mfma_f32_16x16x32_bf16 v[80:83], a[240:243], v[220:223], v[80:83]
    buffer_load_dwordx4 v188, s[20:23], s86 offen offset:3072 lds
    v_mfma_f32_16x16x32_bf16 v[80:83], a[244:247], v[204:207], v[80:83]
    s_add_u32 m0, s99, 65536
    v_mfma_f32_16x16x32_bf16 v[84:87], a[128:131], v[140:143], 0
    s_add_u32 s86, s91, 2048
    v_add_f32 v178, v178, v36
    v_mfma_f32_16x16x32_bf16 v[84:87], a[132:135], v[124:127], v[84:87]
    buffer_store_dwordx4 v[104:107], v74, s[28:31], s58 offen sc1
    v_mfma_f32_16x16x32_bf16 v[84:87], a[136:139], v[108:111], v[84:87]
    s_add_u32 s58, s58, 0x100000
    v_fmac_f32 v180, v37, v37
    v_mfma_f32_16x16x32_bf16 v[84:87], a[140:143], v[240:243], v[84:87]
    ds_write_b128 v172, v[80:83] offset:4096
    v_mfma_f32_16x16x32_bf16 v[84:87], a[144:147], v[224:227], v[84:87]
    buffer_load_dwordx4 v12, s[20:23], s86 offen offset:0 lds
    v_mfma_f32_16x16x32_bf16 v[84:87], a[148:151], v[208:211], v[84:87]
    s_add_u32 s86, s91, 25600
    v_add_f32 v178, v178, v37
    v_mfma_f32_16x16x32_bf16 v[84:87], a[152:155], v[192:195], v[84:87]
    v_fmac_f32 v180, v38, v38
    v_add_f32 v178, v178, v38
    v_mfma_f32_16x16x32_bf16 v[84:87], a[160:163], v[144:147], v[84:87]
    s_waitcnt lgkmcnt(0)
    s_barrier
    v_mfma_f32_16x16x32_bf16 v[84:87], a[164:167], v[128:131], v[84:87]
    ds_read_b64 v[92:93], v73 offset:0
    ds_read_b64 v[94:95], v73 offset:1024
    v_mfma_f32_16x16x32_bf16 v[84:87], a[168:171], v[112:115], v[84:87]
    ds_read_b64 v[96:97], v73 offset:2048
    ds_read_b64 v[98:99], v73 offset:3072
    v_mfma_f32_16x16x32_bf16 v[84:87], a[172:175], v[244:247], v[84:87]
    buffer_load_dwordx4 v188, s[20:23], s86 offen offset:1024 lds
    v_mfma_f32_16x16x32_bf16 v[84:87], a[176:179], v[228:231], v[84:87]
    s_add_u32 s86, s91, 49152
    v_fmac_f32 v180, v39, v39
    v_mfma_f32_16x16x32_bf16 v[84:87], a[180:183], v[212:215], v[84:87]
    v_add_f32 v178, v178, v39
    v_fmac_f32 v180, v40, v40
    v_mfma_f32_16x16x32_bf16 v[84:87], a[184:187], v[196:199], v[84:87]
    v_add_f32 v178, v178, v40
    v_fmac_f32 v180, v41, v41
    v_mfma_f32_16x16x32_bf16 v[84:87], a[192:195], v[148:151], v[84:87]
    v_add_f32_e64 v178, v178, v41
    v_fmac_f32 v180, v42, v42
    v_mfma_f32_16x16x32_bf16 v[84:87], a[196:199], v[132:135], v[84:87]
    buffer_load_dwordx4 v12, s[20:23], s86 offen offset:2048 lds
    v_mfma_f32_16x16x32_bf16 v[84:87], a[200:203], v[116:119], v[84:87]
    s_mov_b64 exec, 0x7f
    buffer_load_dword v191, v186, s[28:31], s51 offen sc1
    s_mov_b64 exec, -1
    v_mfma_f32_16x16x32_bf16 v[84:87], a[204:207], v[248:251], v[84:87]
    s_waitcnt lgkmcnt(2)
    v_add_f32 v92, v92, v94
    v_add_f32 v93, v93, v95
    v_mfma_f32_16x16x32_bf16 v[84:87], a[208:211], v[232:235], v[84:87]
    s_waitcnt lgkmcnt(0)
    v_add_f32 v96, v96, v98
    v_add_f32_e64 v97, v97, v99
    v_mfma_f32_16x16x32_bf16 v[84:87], a[212:215], v[216:219], v[84:87]
    v_cvt_pk_bf16_f32 v100, v92, v96
    v_cvt_pk_bf16_f32 v102, v93, v97
    v_mfma_f32_16x16x32_bf16 v[84:87], a[216:219], v[200:203], v[84:87]
    buffer_store_dwordx4 v[100:103], v74, s[28:31], s58 offen sc1
    v_mfma_f32_16x16x32_bf16 v[84:87], a[224:227], v[152:155], v[84:87]
    s_add_u32 s58, s58, 0x100000
    s_add_u32 s86, s91, 72704
    v_mfma_f32_16x16x32_bf16 v[84:87], a[228:231], v[136:139], v[84:87]
    buffer_load_dwordx4 v188, s[20:23], s86 offen offset:3072 lds
    v_mfma_f32_16x16x32_bf16 v[84:87], a[232:235], v[120:123], v[84:87]
    v_add_f32 v178, v178, v42
    v_fmac_f32 v180, v43, v43
    v_mfma_f32_16x16x32_bf16 v[84:87], a[236:239], v[252:255], v[84:87]
    v_add_f32 v178, v178, v43
    v_fmac_f32 v180, v44, v44
    v_mfma_f32_16x16x32_bf16 v[84:87], a[240:243], v[236:239], v[84:87]
    v_add_f32 v178, v178, v44
    v_fmac_f32 v180, v45, v45
    v_mfma_f32_16x16x32_bf16 v[84:87], a[244:247], v[220:223], v[84:87]
    v_add_f32 v178, v178, v45
    v_fmac_f32 v180, v46, v46
    v_mfma_f32_16x16x32_bf16 v[84:87], a[248:251], v[204:207], v[84:87]
    v_add_f32 v178, v178, v46
    v_fmac_f32 v180, v47, v47
    v_mfma_f32_16x16x32_bf16 v[88:91], a[128:131], v[156:159], 0
    v_add_f32 v178, v178, v47
    v_fmac_f32 v180, v48, v48
    v_mfma_f32_16x16x32_bf16 v[88:91], a[132:135], v[140:143], v[88:91]
    v_add_f32 v178, v178, v48
    v_fmac_f32 v180, v49, v49
    v_mfma_f32_16x16x32_bf16 v[88:91], a[136:139], v[124:127], v[88:91]
    v_add_f32_e64 v178, v178, v49
    v_mfma_f32_16x16x32_bf16 v[88:91], a[140:143], v[108:111], v[88:91]
    ds_write_b128 v172, v[84:87] offset:8192
    v_mfma_f32_16x16x32_bf16 v[88:91], a[144:147], v[240:243], v[88:91]
    v_permlane32_swap_b32 v178, v180
    v_mfma_f32_16x16x32_bf16 v[88:91], a[148:151], v[224:227], v[88:91]
    v_add_f32 v174, v178, v180
    s_lshl_b32 s41, s46, 8
    v_mfma_f32_16x16x32_bf16 v[88:91], a[152:155], v[208:211], v[88:91]
    v_add_u32 v178, s41, v173
    v_mfma_f32_16x16x32_bf16 v[88:91], a[156:159], v[192:195], v[88:91]
    ds_write_b32 v178, v174
    v_mfma_f32_16x16x32_bf16 v[88:91], a[160:163], v[160:163], v[88:91]
    ds_read_b64_tr_b16 a[0:1], v10 offset:0
    ds_read_b64_tr_b16 a[2:3], v10 offset:512
    v_mfma_f32_16x16x32_bf16 v[88:91], a[164:167], v[144:147], v[88:91]
    ds_read_b64_tr_b16 a[4:5], v10 offset:4096
    ds_read_b64_tr_b16 a[6:7], v10 offset:4608
    v_mfma_f32_16x16x32_bf16 v[88:91], a[168:171], v[128:131], v[88:91]
    s_waitcnt lgkmcnt(4)
    s_barrier
    v_mfma_f32_16x16x32_bf16 v[88:91], a[172:175], v[112:115], v[88:91]
    ds_read_b32 v180, v173 offset:0
    ds_read_b32 v181, v173 offset:256
    v_mfma_f32_16x16x32_bf16 v[88:91], a[176:179], v[244:247], v[88:91]
    ds_read_b32 v182, v173 offset:512
    ds_read_b32 v183, v173 offset:768
    v_mfma_f32_16x16x32_bf16 v[88:91], a[180:183], v[228:231], v[88:91]
    s_lshl_b32 s41, s46, 3
    s_lshl_b32 s41, 0xff, s41
    v_mfma_f32_16x16x32_bf16 v[88:91], a[184:187], v[212:215], v[88:91]
    ds_read_b64_tr_b16 a[8:9], v10 offset:8192
    ds_read_b64_tr_b16 a[10:11], v10 offset:8704
    v_mfma_f32_16x16x32_bf16 v[88:91], a[188:191], v[196:199], v[88:91]
    ds_read_b64_tr_b16 a[12:13], v10 offset:12288
    ds_read_b64_tr_b16 a[14:15], v10 offset:12800
    v_mfma_f32_16x16x32_bf16 v[88:91], a[192:195], v[164:167], v[88:91]
    ds_read_b64_tr_b16 a[16:17], v10 offset:16384
    ds_read_b64_tr_b16 a[18:19], v10 offset:16896
    v_mfma_f32_16x16x32_bf16 v[88:91], a[196:199], v[148:151], v[88:91]
    ds_read_b64_tr_b16 a[20:21], v10 offset:20480
    ds_read_b64_tr_b16 a[22:23], v10 offset:20992
    v_mfma_f32_16x16x32_bf16 v[88:91], a[200:203], v[132:135], v[88:91]
    ds_read_b64_tr_b16 a[24:25], v10 offset:24576
    ds_read_b64_tr_b16 a[26:27], v10 offset:25088
    v_mfma_f32_16x16x32_bf16 v[88:91], a[204:207], v[116:119], v[88:91]
    s_waitcnt lgkmcnt(12)
    v_add_f32 v180, v180, v181
    s_waitcnt lgkmcnt(10)
    v_add_f32 v182, v182, v183
    v_mfma_f32_16x16x32_bf16 v[88:91], a[208:211], v[248:251], v[88:91]
    v_add_f32 v174, v180, v182
    v_mfma_f32_16x16x32_bf16 v[88:91], a[212:215], v[232:235], v[88:91]
    s_cmp_eq_u32 s48, 0
    s_cbranch_scc1 L_slowst_14
    s_mov_b32 exec_lo, s41
    s_mov_b32 exec_hi, s41
    buffer_store_dwordx2 v[174:175], v176, s[28:31], s51 offen
    s_mov_b64 exec, -1
L_joinst_15:
    v_mfma_f32_16x16x32_bf16 v[88:91], a[216:219], v[216:219], v[88:91]
    ds_read_b64_tr_b16 a[28:29], v10 offset:28672
    ds_read_b64_tr_b16 a[30:31], v10 offset:29184
    v_mfma_f32_16x16x32_bf16 v[88:91], a[220:223], v[200:203], v[88:91]
    ds_read_b64_tr_b16 a[32:33], v10 offset:32768
    ds_read_b64_tr_b16 a[34:35], v10 offset:33280
    v_mfma_f32_16x16x32_bf16 v[88:91], a[224:227], v[168:171], v[88:91]
    ds_read_b64_tr_b16 a[36:37], v10 offset:36864
    ds_read_b64_tr_b16 a[38:39], v10 offset:37376
    v_mfma_f32_16x16x32_bf16 v[88:91], a[228:231], v[152:155], v[88:91]
    ds_read_b64_tr_b16 a[40:41], v10 offset:40960
    ds_read_b64_tr_b16 a[42:43], v10 offset:41472
    v_mfma_f32_16x16x32_bf16 v[88:91], a[232:235], v[136:139], v[88:91]
    ds_read_b64_tr_b16 a[44:45], v10 offset:45056
    ds_read_b64_tr_b16 a[46:47], v10 offset:45568
    v_mfma_f32_16x16x32_bf16 v[88:91], a[236:239], v[120:123], v[88:91]
    ds_read_b64_tr_b16 a[48:49], v10 offset:49152
    ds_read_b64_tr_b16 a[50:51], v10 offset:49664
    v_mfma_f32_16x16x32_bf16 v[88:91], a[240:243], v[252:255], v[88:91]
    ds_read_b64_tr_b16 a[52:53], v10 offset:53248
    ds_read_b64_tr_b16 a[54:55], v10 offset:53760
    v_mfma_f32_16x16x32_bf16 v[88:91], a[244:247], v[236:239], v[88:91]
    ds_read_b64_tr_b16 a[56:57], v10 offset:57344
    ds_read_b64_tr_b16 a[58:59], v10 offset:57856
    v_mfma_f32_16x16x32_bf16 v[88:91], a[248:251], v[220:223], v[88:91]
    ds_read_b64_tr_b16 a[60:61], v10 offset:61440
    ds_read_b64_tr_b16 a[62:63], v10 offset:61952
    v_mfma_f32_16x16x32_bf16 v[88:91], a[252:255], v[204:207], v[88:91]
    s_nop 7
    ds_write_b128 v172, v[88:91] offset:12288
    s_waitcnt lgkmcnt(0)
    s_barrier
    ds_read_b64 v[92:93], v73 offset:8192
    ds_read_b64 v[94:95], v73 offset:9216
    ds_read_b64 v[96:97], v73 offset:10240
    ds_read_b64 v[98:99], v73 offset:11264
    v_and_b32 v187, 0xff, v2
    v_add_u32 v187, 0x69100, v187
    buffer_load_dwordx2 v[184:185], v187, s[28:31], s51 offen offset:0 sc1
    s_waitcnt lgkmcnt(2)
    v_add_f32 v92, v92, v94
    v_add_f32 v93, v93, v95
    s_waitcnt lgkmcnt(0)
    v_add_f32 v96, v96, v98
    v_add_f32 v97, v97, v99
    v_cvt_pk_bf16_f32 v104, v92, v96
    v_cvt_pk_bf16_f32 v106, v93, v97
    buffer_store_dwordx4 v[104:107], v74, s[28:31], s58 offen sc1
    s_add_u32 m0, s96, 0
    s_add_u32 s86, s88, 0
    buffer_load_dwordx4 v12, s[20:23], s86 offen offset:0 lds
    s_add_u32 s86, s88, 23552
    buffer_load_dwordx4 v188, s[20:23], s86 offen offset:1024 lds
    s_add_u32 s86, s88, 47104
    buffer_load_dwordx4 v12, s[20:23], s86 offen offset:2048 lds
    s_add_u32 s86, s88, 70656
    buffer_load_dwordx4 v188, s[20:23], s86 offen offset:3072 lds
    v_add_u32 v0, 0x10000, v1
    s_waitcnt vmcnt(7)
    s_barrier
    v_mfma_f32_16x16x32_bf16 v[76:79], v[24:27], a[0:3], 0
    v_add_u32 v190, 0x10000, v10
    v_mfma_f32_16x16x32_bf16 v[76:79], v[24:27], a[4:7], v[76:79]
    ds_read_b64_tr_b16 a[64:65], v190 offset:0
    ds_read_b64_tr_b16 a[66:67], v190 offset:512
    v_mfma_f32_16x16x32_bf16 v[76:79], v[24:27], a[8:11], v[76:79]
    ds_read_b64_tr_b16 a[68:69], v190 offset:4096
    ds_read_b64_tr_b16 a[70:71], v190 offset:4608
    v_mfma_f32_16x16x32_bf16 v[76:79], v[24:27], a[12:15], v[76:79]
    ds_read_b64_tr_b16 a[72:73], v190 offset:8192
    ds_read_b64_tr_b16 a[74:75], v190 offset:8704
    v_mfma_f32_16x16x32_bf16 v[76:79], v[24:27], a[16:19], v[76:79]
    ds_read_b64_tr_b16 a[76:77], v190 offset:12288
    ds_read_b64_tr_b16 a[78:79], v190 offset:12800
    v_mfma_f32_16x16x32_bf16 v[76:79], v[24:27], a[20:23], v[76:79]
    ds_read_b64_tr_b16 a[80:81], v190 offset:16384
    ds_read_b64_tr_b16 a[82:83], v190 offset:16896
    v_mfma_f32_16x16x32_bf16 v[76:79], v[24:27], a[24:27], v[76:79]
    ds_read_b64_tr_b16 a[84:85], v190 offset:20480
    ds_read_b64_tr_b16 a[86:87], v190 offset:20992
    v_mfma_f32_16x16x32_bf16 v[76:79], v[24:27], a[28:31], v[76:79]
    ds_read_b64_tr_b16 a[88:89], v190 offset:24576
    ds_read_b64_tr_b16 a[90:91], v190 offset:25088
    v_mfma_f32_16x16x32_bf16 v[76:79], v[24:27], a[32:35], v[76:79]
    ds_read_b64_tr_b16 a[92:93], v190 offset:28672
    ds_read_b64_tr_b16 a[94:95], v190 offset:29184
    v_mfma_f32_16x16x32_bf16 v[76:79], v[24:27], a[36:39], v[76:79]
    ds_read_b64_tr_b16 a[96:97], v190 offset:32768
    ds_read_b64_tr_b16 a[98:99], v190 offset:33280
    v_mfma_f32_16x16x32_bf16 v[76:79], v[24:27], a[40:43], v[76:79]
    ds_read_b64_tr_b16 a[100:101], v190 offset:36864
    ds_read_b64_tr_b16 a[102:103], v190 offset:37376
    v_mfma_f32_16x16x32_bf16 v[76:79], v[24:27], a[44:47], v[76:79]
    ds_read_b64_tr_b16 a[104:105], v190 offset:40960
    ds_read_b64_tr_b16 a[106:107], v190 offset:41472
    v_mfma_f32_16x16x32_bf16 v[76:79], v[24:27], a[48:51], v[76:79]
    ds_read_b64_tr_b16 a[108:109], v190 offset:45056
    ds_read_b64_tr_b16 a[110:111], v190 offset:45568
    v_mfma_f32_16x16x32_bf16 v[76:79], v[24:27], a[52:55], v[76:79]
    ds_read_b64_tr_b16 a[112:113], v190 offset:49152
    ds_read_b64_tr_b16 a[114:115], v190 offset:49664
    v_mfma_f32_16x16x32_bf16 v[76:79], v[24:27], a[56:59], v[76:79]
    ds_read_b64_tr_b16 a[116:117], v190 offset:53248
    ds_read_b64_tr_b16 a[118:119], v190 offset:53760
    v_mfma_f32_16x16x32_bf16 v[76:79], v[24:27], a[60:63], v[76:79]
    ds_read_b64_tr_b16 a[120:121], v190 offset:57344
    ds_read_b64_tr_b16 a[122:123], v190 offset:57856
    ds_read_b64_tr_b16 a[124:125], v190 offset:61440
    ds_read_b64_tr_b16 a[126:127], v190 offset:61952
    buffer_load_dwordx4 v[108:111], v177, s[28:31], s51 offen offset:0 sc1
    buffer_load_dwordx4 v[112:115], v177, s[28:31], s51 offen offset:512 sc1
    buffer_load_dwordx4 v[156:159], v4, s[28:31], s36 offen offset:0 sc1
    buffer_load_dwordx4 v[160:163], v4, s[28:31], s36 offen offset:256 sc1
    buffer_load_dwordx4 v[164:167], v4, s[28:31], s36 offen offset:512 sc1
    buffer_load_dwordx4 v[168:171], v4, s[28:31], s36 offen offset:768 sc1
    s_waitcnt vmcnt(11)
    v_cmp_ne_u64 vcc, s[42:43], v[184:185]
    s_nop 0
    s_cbranch_vccz L_latedone_17
    s_mov_b32 s50, s49
L_late_16:
    buffer_load_dwordx2 v[184:185], v187, s[28:31], s51 offen offset:0 sc1
    s_waitcnt vmcnt(0)
    v_cmp_ne_u64 vcc, s[42:43], v[184:185]
    s_nop 0
    s_cbranch_vccz L_latedone_17
    s_sub_u32 s50, s50, 1
    s_cbranch_scc0 L_late_16
    s_mov_b32 s49, 0
    s_or_b32 s72, s72, 2
L_latedone_17:
    s_waitcnt vmcnt(5)
    v_bitop3_b32 v144, v109, v111, s69 bitop3:0x7e
    s_waitcnt vmcnt(4)
    v_bitop3_b32 v145, v113, v115, s69 bitop3:0x7e
    v_or_b32 v144, v144, v145
    v_cmp_ne_u32 vcc, 0, v144
    s_nop 0
    s_cbranch_vccz L_latedone_20
    s_mov_b32 s50, s49
L_late_19:
    buffer_load_dwordx4 v[108:111], v177, s[28:31], s51 offen offset:0 sc1
    buffer_load_dwordx4 v[112:115], v177, s[28:31], s51 offen offset:512 sc1
    s_waitcnt vmcnt(1)
    v_bitop3_b32 v144, v109, v111, s69 bitop3:0x7e
    s_waitcnt vmcnt(0)
    v_bitop3_b32 v145, v113, v115, s69 bitop3:0x7e
    v_or_b32 v144, v144, v145
    v_cmp_ne_u32 vcc, 0, v144
    s_nop 0
    s_cbranch_vccz L_latedone_20
    s_sub_u32 s50, s50, 1
    s_cbranch_scc0 L_late_19
    s_mov_b32 s49, 0
    s_or_b32 s72, s72, 2048
L_latedone_20:
    s_waitcnt lgkmcnt(15)
    v_mfma_f32_16x16x32_bf16 v[132:135], v[24:27], a[64:67], 0
    s_add_u32 m0, s97, 0
    s_add_u32 s86, s89, 0
    v_mfma_f32_16x16x32_bf16 v[132:135], v[24:27], a[68:71], v[132:135]
    buffer_load_dwordx4 v12, s[20:23], s86 offen offset:0 lds
    v_mfma_f32_16x16x32_bf16 v[132:135], v[24:27], a[72:75], v[132:135]
    s_add_u32 s86, s89, 23552
    v_add_f32_e64 v108, v108, v112
    v_mfma_f32_16x16x32_bf16 v[132:135], v[24:27], a[76:79], v[132:135]
    buffer_load_dwordx4 v188, s[20:23], s86 offen offset:1024 lds
    v_mfma_f32_16x16x32_bf16 v[132:135], v[24:27], a[80:83], v[132:135]
    s_add_u32 s86, s89, 47104
    v_add_f32_e64 v109, v110, v114
    v_mfma_f32_16x16x32_bf16 v[132:135], v[24:27], a[84:87], v[132:135]
    buffer_load_dwordx4 v12, s[20:23], s86 offen offset:2048 lds
    v_mfma_f32_16x16x32_bf16 v[132:135], v[24:27], a[88:91], v[132:135]
    s_add_u32 s86, s89, 70656
    v_mfma_f32_16x16x32_bf16 v[132:135], v[24:27], a[92:95], v[132:135]
    buffer_load_dwordx4 v188, s[20:23], s86 offen offset:3072 lds
    s_waitcnt lgkmcnt(14)
    v_mfma_f32_16x16x32_bf16 v[132:135], v[24:27], a[96:99], v[132:135]
    s_add_u32 m0, s98, 0
    s_add_u32 s86, s90, 0
    s_waitcnt lgkmcnt(12)
    v_mfma_f32_16x16x32_bf16 v[132:135], v[24:27], a[100:103], v[132:135]
    buffer_load_dwordx4 v12, s[20:23], s86 offen offset:0 lds
    s_waitcnt lgkmcnt(10)
    v_mfma_f32_16x16x32_bf16 v[132:135], v[24:27], a[104:107], v[132:135]
    s_add_u32 s86, s90, 23552
    s_waitcnt lgkmcnt(8)
    v_mfma_f32_16x16x32_bf16 v[132:135], v[24:27], a[108:111], v[132:135]
    buffer_load_dwordx4 v188, s[20:23], s86 offen offset:1024 lds
    s_waitcnt lgkmcnt(6)
    v_mfma_f32_16x16x32_bf16 v[132:135], v[24:27], a[112:115], v[132:135]
    s_add_u32 s86, s90, 47104
    s_waitcnt lgkmcnt(4)
    v_mfma_f32_16x16x32_bf16 v[132:135], v[24:27], a[116:119], v[132:135]
    buffer_load_dwordx4 v12, s[20:23], s86 offen offset:2048 lds
    s_waitcnt lgkmcnt(2)
    v_mfma_f32_16x16x32_bf16 v[132:135], v[24:27], a[120:123], v[132:135]
    s_add_u32 s86, s90, 70656
    s_waitcnt lgkmcnt(0)
    v_mfma_f32_16x16x32_bf16 v[132:135], v[24:27], a[124:127], v[132:135]
    buffer_load_dwordx4 v188, s[20:23], s86 offen offset:3072 lds
    v_permlane32_swap_b32 v108, v109
    v_add_f32 v108, v108, v109
    v_mul_f32 v108, s68, v108
    v_mov_b32 v109, v108
    s_nop 1
    v_permlane32_swap_b32 v108, v109
    v_fma_f32 v109, -v108, v108, v109
    v_max_f32 v109, 0, v109
    v_add_f32 v109, s67, v109
    v_rsq_f32 v136, v109
    s_nop 0
    v_mul_f32 v138, -v108, v136
    v_pk_fma_f32 v[116:117], v[34:35], v[136:137], v[138:139] op_sel_hi:[1,0,0]
    v_pk_fma_f32 v[118:119], v[36:37], v[136:137], v[138:139] op_sel_hi:[1,0,0]
    v_pk_fma_f32 v[120:121], v[38:39], v[136:137], v[138:139] op_sel_hi:[1,0,0]
    v_pk_fma_f32 v[122:123], v[40:41], v[136:137], v[138:139] op_sel_hi:[1,0,0]
    v_pk_fma_f32 v[124:125], v[42:43], v[136:137], v[138:139] op_sel_hi:[1,0,0]
    v_pk_fma_f32 v[126:127], v[44:45], v[136:137], v[138:139] op_sel_hi:[1,0,0]
    v_pk_fma_f32 v[128:129], v[46:47], v[136:137], v[138:139] op_sel_hi:[1,0,0]
    v_pk_fma_f32 v[130:131], v[48:49], v[136:137], v[138:139] op_sel_hi:[1,0,0]
    v_mov_b32 v28, v76
    v_mov_b32 v29, v132
    s_waitcnt vmcnt(11)
    v_bitop3_b32 v80, v157, v159, s69 bitop3:0x7e
    s_waitcnt vmcnt(10)
    v_bitop3_b32 v81, v161, v163, s69 bitop3:0x7e
    s_waitcnt vmcnt(9)
    v_bitop3_b32 v82, v165, v167, s69 bitop3:0x7e
    s_waitcnt vmcnt(8)
    v_bitop3_b32 v83, v169, v171, s69 bitop3:0x7e
    v_or3_b32 v80, v80, v81, v82
    v_or_b32_e64 v80, v80, v83
    v_cmp_ne_u32 vcc, 0, v80
    s_nop 0
    s_cbranch_vccz L_latedone_23
    s_mov_b32 s50, s49
L_late_22:
    buffer_load_dwordx4 v[156:159], v4, s[28:31], s36 offen offset:0 sc1
    buffer_load_dwordx4 v[160:163], v4, s[28:31], s36 offen offset:256 sc1
    buffer_load_dwordx4 v[164:167], v4, s[28:31], s36 offen offset:512 sc1
    buffer_load_dwordx4 v[168:171], v4, s[28:31], s36 offen offset:768 sc1
    s_waitcnt vmcnt(3)
    v_bitop3_b32 v80, v157, v159, s69 bitop3:0x7e
    s_waitcnt vmcnt(2)
    v_bitop3_b32 v81, v161, v163, s69 bitop3:0x7e
    s_waitcnt vmcnt(1)
    v_bitop3_b32 v82, v165, v167, s69 bitop3:0x7e
    s_waitcnt vmcnt(0)
    v_bitop3_b32 v83, v169, v171, s69 bitop3:0x7e
    v_or3_b32 v80, v80, v81, v82
    v_or_b32 v80, v80, v83
    v_cmp_ne_u32 vcc, 0, v80
    s_nop 0
    s_cbranch_vccz L_latedone_23
    s_sub_u32 s50, s50, 1
    s_cbranch_scc0 L_late_22
    s_mov_b32 s49, 0
    s_or_b32 s72, s72, 4
L_latedone_23:
    v_permlane16_swap_b32 v156, v158
    v_permlane16_swap_b32 v160, v162
    v_permlane16_swap_b32 v164, v166
    v_permlane16_swap_b32 v168, v170
    v_lshlrev_b32 v50, 16, v156
    v_and_b32 v51, s59, v156
    v_lshlrev_b32 v52, 16, v160
    v_and_b32 v53, s59, v160
    v_lshlrev_b32 v54, 16, v164
    v_and_b32 v55, s59, v164
    v_lshlrev_b32 v56, 16, v168
    v_and_b32 v57, s59, v168
    v_pk_fma_f32 v[34:35], v[116:117], v[50:51], v[34:35]
    v_pk_fma_f32 v[36:37], v[118:119], v[52:53], v[36:37]
    v_pk_fma_f32 v[38:39], v[120:121], v[54:55], v[38:39]
    v_pk_fma_f32 v[40:41], v[122:123], v[56:57], v[40:41]
    v_cvt_pk_bf16_f32 v132, v34, v35
    v_cvt_pk_bf16_f32 v133, v36, v37
    v_cvt_pk_bf16_f32 v134, v38, v39
    v_cvt_pk_bf16_f32 v135, v40, v41
    s_cmp_eq_u32 s48, 0
    s_cbranch_scc1 L_slowst_25
    buffer_store_dwordx4 v[132:135], v7, s[28:31], s51 offen offset:0
L_joinst_26:
    v_lshlrev_b32 v58, 16, v158
    v_and_b32 v59, s59, v158
    v_lshlrev_b32 v60, 16, v162
    v_and_b32 v61, s59, v162
    v_lshlrev_b32 v62, 16, v166
    v_and_b32 v63, s59, v166
    v_lshlrev_b32 v64, 16, v170
    v_and_b32 v65, s59, v170
    v_pk_fma_f32 v[42:43], v[124:125], v[58:59], v[42:43]
    v_pk_fma_f32 v[44:45], v[126:127], v[60:61], v[44:45]
    v_pk_fma_f32 v[46:47], v[128:129], v[62:63], v[46:47]
    v_pk_fma_f32 v[48:49], v[130:131], v[64:65], v[48:49]
    v_cvt_pk_bf16_f32 v136, v42, v43
    v_cvt_pk_bf16_f32 v137, v44, v45
    v_cvt_pk_bf16_f32 v138, v46, v47
    v_cvt_pk_bf16_f32 v139, v48, v49
    s_cmp_eq_u32 s48, 0
    s_cbranch_scc1 L_slowst_27
    buffer_store_dwordx4 v[136:139], v7, s[28:31], s51 offen offset:256
L_joinst_28:
    s_add_u32 m0, s99, 0
    s_add_u32 s86, s91, 0
    buffer_load_dwordx4 v12, s[20:23], s86 offen offset:0 lds
    v_pk_mul_f32 v[128:129], v[34:35], v[34:35]
    v_pk_add_f32 v[126:127], v[34:35], v[36:37]
    v_pk_fma_f32 v[128:129], v[36:37], v[36:37], v[128:129]
    v_pk_fma_f32 v[128:129], v[38:39], v[38:39], v[128:129]
    v_pk_add_f32 v[126:127], v[126:127], v[38:39]
    v_pk_fma_f32 v[128:129], v[40:41], v[40:41], v[128:129]
    s_add_u32 s86, s91, 23552
    buffer_load_dwordx4 v188, s[20:23], s86 offen offset:1024 lds
    v_pk_add_f32 v[126:127], v[126:127], v[40:41]
    v_pk_fma_f32 v[128:129], v[42:43], v[42:43], v[128:129]
    v_pk_add_f32 v[126:127], v[126:127], v[42:43]
    v_pk_fma_f32 v[128:129], v[44:45], v[44:45], v[128:129]
    v_pk_add_f32 v[126:127], v[126:127], v[44:45]
    v_pk_fma_f32 v[128:129], v[46:47], v[46:47], v[128:129]
    s_add_u32 s86, s91, 47104
    buffer_load_dwordx4 v12, s[20:23], s86 offen offset:2048 lds
    v_pk_add_f32 v[126:127], v[126:127], v[46:47]
    v_pk_fma_f32 v[128:129], v[48:49], v[48:49], v[128:129]
    v_pk_add_f32 v[126:127], v[126:127], v[48:49]
    v_add_f32 v126, v126, v127
    v_add_f32 v128, v128, v129
    s_nop 1
    v_permlane32_swap_b32 v126, v128
    v_add_f32 v124, v126, v128
    s_lshl_b32 s54, s46, 8
    v_lshrrev_b32 v72, 2, v1
    v_add_u32 v72, 0x26400, v72
    v_add_u32 v73, s54, v72
    ds_write_b32 v73, v124
    v_and_b32 v4, 0x7f, v2
    s_waitcnt vmcnt(3)
    s_cmp_eq_u32 s48, 0
    s_cbranch_scc1 L_slowst_29
    s_mov_b64 exec, 1
    buffer_store_dwordx2 v[18:19], off, s[28:31], s3 offset:0
    s_mov_b64 exec, -1
L_joinst_30:
    s_add_u32 s86, s91, 70656
    buffer_load_dwordx4 v188, s[20:23], s86 offen offset:3072 lds
    s_add_u32 m0, s73, 65536
    s_mov_b32 s53, s83
    s_waitcnt vmcnt(0)
    s_waitcnt lgkmcnt(0)
    s_barrier
    buffer_load_dwordx2 v[140:141], v4, s[28:31], s60 offen offset:0 sc1
    ds_read_b32 v108, v72 offset:0
    ds_read_b32 v109, v72 offset:256
    ds_read_b32 v110, v72 offset:512
    ds_read_b32 v111, v72 offset:768
    s_waitcnt lgkmcnt(2)
    v_add_f32 v108, v108, v109
    s_waitcnt lgkmcnt(0)
    v_add_f32 v110, v110, v111
    v_add_f32 v108, v108, v110
    v_min_u32 v108, -2, v108
    s_cmp_eq_u32 s48, 0
    s_cbranch_scc1 L_slowst_31
    s_mov_b32 exec_lo, s41
    s_mov_b32 exec_hi, s41
    buffer_store_dword v108, v5, s[28:31], s18 offen
    s_mov_b64 exec, -1
L_joinst_32:
    ds_read_b64_tr_b16 a[128:129], v10 offset:0
    ds_read_b64_tr_b16 a[130:131], v10 offset:512
    ds_read_b64_tr_b16 a[132:133], v10 offset:4096
    ds_read_b64_tr_b16 a[134:135], v10 offset:4608
    ds_read_b64_tr_b16 a[136:137], v10 offset:8192
    ds_read_b64_tr_b16 a[138:139], v10 offset:8704
    ds_read_b64_tr_b16 a[140:141], v10 offset:12288
    ds_read_b64_tr_b16 a[142:143], v10 offset:12800
    ds_read_b64_tr_b16 a[144:145], v10 offset:16384
    ds_read_b64_tr_b16 a[146:147], v10 offset:16896
    ds_read_b64_tr_b16 a[148:149], v10 offset:20480
    ds_read_b64_tr_b16 a[150:151], v10 offset:20992
    ds_read_b64_tr_b16 a[152:153], v10 offset:24576
    ds_read_b64_tr_b16 a[154:155], v10 offset:25088
    ds_read_b64_tr_b16 a[156:157], v10 offset:28672
    ds_read_b64_tr_b16 a[158:159], v10 offset:29184
    ds_read_b64_tr_b16 a[160:161], v10 offset:32768
    ds_read_b64_tr_b16 a[162:163], v10 offset:33280
    ds_read_b64_tr_b16 a[164:165], v10 offset:36864
    ds_read_b64_tr_b16 a[166:167], v10 offset:37376
    ds_read_b64_tr_b16 a[168:169], v10 offset:40960
    ds_read_b64_tr_b16 a[170:171], v10 offset:41472
    ds_read_b64_tr_b16 a[172:173], v10 offset:45056
    ds_read_b64_tr_b16 a[174:175], v10 offset:45568
    ds_read_b64_tr_b16 a[176:177], v10 offset:49152
    ds_read_b64_tr_b16 a[178:179], v10 offset:49664
    ds_read_b64_tr_b16 a[180:181], v10 offset:53248
    ds_read_b64_tr_b16 a[182:183], v10 offset:53760
    ds_read_b64_tr_b16 a[184:185], v10 offset:57344
    ds_read_b64_tr_b16 a[186:187], v10 offset:57856
    ds_read_b64_tr_b16 a[188:189], v10 offset:61440
    ds_read_b64_tr_b16 a[190:191], v10 offset:61952
    s_waitcnt vmcnt(1)
    v_cmp_ne_u64 vcc, s[42:43], v[140:141]
    s_nop 0
    s_cbranch_vccz L_latedone_34
    s_mov_b32 s50, s49
L_late_33:
    buffer_load_dwordx2 v[140:141], v4, s[28:31], s60 offen offset:0 sc1
    s_waitcnt vmcnt(0)
    v_cmp_ne_u64 vcc, s[42:43], v[140:141]
    s_nop 0
    s_cbranch_vccz L_latedone_34
    s_sub_u32 s50, s50, 1
    s_cbranch_scc0 L_late_33
    s_mov_b32 s49, 0
    s_or_b32 s72, s72, 8
L_latedone_34:
    buffer_load_dwordx4 v1, s[28:31], s53 offen offset:0 sc1 lds
    buffer_load_dwordx4 v1, s[28:31], s53 offen offset:1024 sc1 lds
    s_waitcnt lgkmcnt(15)
    v_mfma_f32_16x16x32_bf16 v[108:111], a[128:131], v[24:27], 0
    buffer_load_dwordx4 v1, s[28:31], s53 offen offset:2048 sc1 lds
    v_mfma_f32_16x16x32_bf16 v[108:111], a[132:135], v[24:27], v[108:111]
    v_mfma_f32_16x16x32_bf16 v[108:111], a[136:139], v[24:27], v[108:111]
    buffer_load_dwordx4 v1, s[28:31], s53 offen offset:3072 sc1 lds
    v_mfma_f32_16x16x32_bf16 v[108:111], a[140:143], v[24:27], v[108:111]
    s_add_u32 m0, m0, 4096
    s_add_u32 s53, s53, 0x1000
    v_mfma_f32_16x16x32_bf16 v[108:111], a[144:147], v[24:27], v[108:111]
    buffer_load_dwordx4 v1, s[28:31], s53 offen offset:0 sc1 lds
    v_mfma_f32_16x16x32_bf16 v[108:111], a[148:151], v[24:27], v[108:111]
    v_mfma_f32_16x16x32_bf16 v[108:111], a[152:155], v[24:27], v[108:111]
    buffer_load_dwordx4 v1, s[28:31], s53 offen offset:1024 sc1 lds
    v_mfma_f32_16x16x32_bf16 v[108:111], a[156:159], v[24:27], v[108:111]
    s_waitcnt lgkmcnt(14)
    v_mfma_f32_16x16x32_bf16 v[108:111], a[160:163], v[24:27], v[108:111]
    buffer_load_dwordx4 v1, s[28:31], s53 offen offset:2048 sc1 lds
    s_waitcnt lgkmcnt(12)
    v_mfma_f32_16x16x32_bf16 v[108:111], a[164:167], v[24:27], v[108:111]
    s_waitcnt lgkmcnt(10)
    v_mfma_f32_16x16x32_bf16 v[108:111], a[168:171], v[24:27], v[108:111]
    buffer_load_dwordx4 v1, s[28:31], s53 offen offset:3072 sc1 lds
    s_waitcnt lgkmcnt(8)
    v_mfma_f32_16x16x32_bf16 v[108:111], a[172:175], v[24:27], v[108:111]
    s_waitcnt lgkmcnt(6)
    v_mfma_f32_16x16x32_bf16 v[108:111], a[176:179], v[24:27], v[108:111]
    s_waitcnt lgkmcnt(4)
    v_mfma_f32_16x16x32_bf16 v[108:111], a[180:183], v[24:27], v[108:111]
    s_waitcnt lgkmcnt(2)
    v_mfma_f32_16x16x32_bf16 v[108:111], a[184:187], v[24:27], v[108:111]
    s_waitcnt lgkmcnt(0)
    v_mfma_f32_16x16x32_bf16 v[108:111], a[188:191], v[24:27], v[108:111]
    s_nop 7
    v_mov_b32 v30, v108
    v_mov_b32 v31, v109
    v_mov_b32 v32, v110
    v_mov_b32_e64 v33, v111
    s_waitcnt vmcnt(6)
    s_barrier
    ds_read_b128 v[76:79], v0 offset:0
    ds_read_b128 v[80:83], v0 offset:16384
    ds_read_b128 v[84:87], v0 offset:32768
    ds_read_b128 v[88:91], v0 offset:49152
    s_waitcnt lgkmcnt(3)
    v_mfma_f32_16x16x32_bf16 v[108:111], v[76:79], a[0:3], 0
    ds_read_b128 v[92:95], v0 offset:1024
    s_add_u32 m0, m0, 4096
    v_mfma_f32_16x16x32_bf16 v[124:127], v[76:79], a[64:67], 0
    ds_read_b128 v[96:99], v0 offset:17408
    s_add_u32 s53, s53, 0x1000
    s_waitcnt lgkmcnt(4)
    v_mfma_f32_16x16x32_bf16 v[112:115], v[80:83], a[0:3], 0
    ds_read_b128 v[100:103], v0 offset:33792
    s_and_b32 s76, s74, 31
    v_mfma_f32_16x16x32_bf16 v[128:131], v[80:83], a[64:67], 0
    ds_read_b128 v[104:107], v0 offset:50176
    s_lshl_b32 s8, s76, 7
    s_waitcnt lgkmcnt(5)
    v_mfma_f32_16x16x32_bf16 v[116:119], v[84:87], a[0:3], 0
    buffer_load_dwordx4 v1, s[28:31], s53 offen offset:0 sc1 lds
    v_mfma_f32_16x16x32_bf16 v[132:135], v[84:87], a[64:67], 0
    s_lshl2_add_u32 s8, s44, s8
    s_add_u32 s8, s8, s63
    s_waitcnt lgkmcnt(4)
    v_mfma_f32_16x16x32_bf16 v[120:123], v[88:91], a[0:3], 0
    buffer_load_dwordx2 v[172:173], v189, s[28:31], s18 offen sc1
    v_mfma_f32_16x16x32_bf16 v[136:139], v[88:91], a[64:67], 0
    s_waitcnt vmcnt(6)
    s_barrier
    s_waitcnt lgkmcnt(0)
    v_mfma_f32_16x16x32_bf16 v[108:111], v[92:95], a[4:7], v[108:111]
    ds_read_b128 v[76:79], v0 offset:2048
    s_lshl_b32 s77, s8, 7
    v_mfma_f32_16x16x32_bf16 v[124:127], v[92:95], a[68:71], v[124:127]
    ds_read_b128 v[80:83], v0 offset:18432
    s_add_u32 s77, s77, 0x80000
    v_mfma_f32_16x16x32_bf16 v[112:115], v[96:99], a[4:7], v[112:115]
    ds_read_b128 v[84:87], v0 offset:34816
    s_lshl_b32 s8, s8, 4
    v_mfma_f32_16x16x32_bf16 v[128:131], v[96:99], a[68:71], v[128:131]
    ds_read_b128 v[88:91], v0 offset:51200
    s_add_u32 s8, s8, 0x180000
    v_mfma_f32_16x16x32_bf16 v[116:119], v[100:103], a[4:7], v[116:119]
    buffer_load_dwordx4 v1, s[28:31], s53 offen offset:1024 sc1 lds
    v_mfma_f32_16x16x32_bf16 v[132:135], v[100:103], a[68:71], v[132:135]
    v_and_b32 v191, 0x300, v1
    v_lshlrev_b32 v16, 1, v191
    v_mfma_f32_16x16x32_bf16 v[120:123], v[104:107], a[4:7], v[120:123]
    buffer_load_dwordx4 v1, s[28:31], s53 offen offset:2048 sc1 lds
    v_mfma_f32_16x16x32_bf16 v[136:139], v[104:107], a[68:71], v[136:139]
    v_and_b32 v190, 0x78, v2
    s_waitcnt lgkmcnt(0)
    v_mfma_f32_16x16x32_bf16 v[108:111], v[76:79], a[8:11], v[108:111]
    ds_read_b128 v[92:95], v0 offset:3072
    v_lshl_add_u32 v9, v191, 4, v190
    v_mfma_f32_16x16x32_bf16 v[124:127], v[76:79], a[72:75], v[124:127]
    ds_read_b128 v[96:99], v0 offset:19456
    s_lshl_b32 s76, s76, 10
    v_mfma_f32_16x16x32_bf16 v[112:115], v[80:83], a[8:11], v[112:115]
    ds_read_b128 v[100:103], v0 offset:35840
    s_lshl2_add_u32 s37, s44, s63
    v_mfma_f32_16x16x32_bf16 v[128:131], v[80:83], a[72:75], v[128:131]
    ds_read_b128 v[104:107], v0 offset:52224
    s_lshl_b32 s37, s37, 17
    v_mfma_f32_16x16x32_bf16 v[116:119], v[84:87], a[8:11], v[116:119]
    buffer_load_dwordx4 v1, s[28:31], s53 offen offset:3072 sc1 lds
    v_mfma_f32_16x16x32_bf16 v[132:135], v[84:87], a[72:75], v[132:135]
    s_add_u32 m0, m0, 4096
    s_add_u32 s53, s53, 0x1000
    v_mfma_f32_16x16x32_bf16 v[120:123], v[88:91], a[8:11], v[120:123]
    buffer_load_dwordx4 v1, s[28:31], s53 offen offset:0 sc1 lds
    v_mfma_f32_16x16x32_bf16 v[136:139], v[88:91], a[72:75], v[136:139]
    s_waitcnt vmcnt(7)
    s_barrier
    s_waitcnt lgkmcnt(0)
    v_mfma_f32_16x16x32_bf16 v[108:111], v[92:95], a[12:15], v[108:111]
    ds_read_b128 v[76:79], v0 offset:4096
    s_add_u32 s76, s76, s37
    v_mfma_f32_16x16x32_bf16 v[124:127], v[92:95], a[76:79], v[124:127]
    ds_read_b128 v[80:83], v0 offset:20480
    v_and_b32 v190, 0x2f0, v1
    v_mfma_f32_16x16x32_bf16 v[112:115], v[96:99], a[12:15], v[112:115]
    ds_read_b128 v[84:87], v0 offset:36864
    v_bfe_u32 v191, v1, 8, 1
    v_mfma_f32_16x16x32_bf16 v[128:131], v[96:99], a[76:79], v[128:131]
    ds_read_b128 v[88:91], v0 offset:53248
    v_lshl_add_u32 v190, v191, 3, v190
    v_mfma_f32_16x16x32_bf16 v[116:119], v[100:103], a[12:15], v[116:119]
    buffer_load_dwordx4 v1, s[28:31], s53 offen offset:1024 sc1 lds
    v_mfma_f32_16x16x32_bf16 v[132:135], v[100:103], a[76:79], v[132:135]
    v_add_u32_e64 v8, s76, v190
    s_mov_b32 s37, 0x210000
    v_mfma_f32_16x16x32_bf16 v[120:123], v[104:107], a[12:15], v[120:123]
    buffer_load_dwordx4 v1, s[28:31], s53 offen offset:2048 sc1 lds
    v_mfma_f32_16x16x32_bf16 v[136:139], v[104:107], a[76:79], v[136:139]
    s_lshr_b32 s10, s9, 3
    s_waitcnt lgkmcnt(0)
    v_mfma_f32_16x16x32_bf16 v[108:111], v[76:79], a[16:19], v[108:111]
    ds_read_b128 v[92:95], v0 offset:5120
    s_add_u32 s10, s10, 0x180000
    v_mfma_f32_16x16x32_bf16 v[124:127], v[76:79], a[80:83], v[124:127]
    ds_read_b128 v[96:99], v0 offset:21504
    s_add_u32 s9, s9, 0x80000
    v_mfma_f32_16x16x32_bf16 v[112:115], v[80:83], a[16:19], v[112:115]
    ds_read_b128 v[100:103], v0 offset:37888
    s_mov_b32 s16, 0
    v_mfma_f32_16x16x32_bf16 v[128:131], v[80:83], a[80:83], v[128:131]
    ds_read_b128 v[104:107], v0 offset:54272
    s_mov_b32 s17, -1
    v_mfma_f32_16x16x32_bf16 v[116:119], v[84:87], a[16:19], v[116:119]
    buffer_load_dwordx4 v1, s[28:31], s53 offen offset:3072 sc1 lds
    v_mfma_f32_16x16x32_bf16 v[132:135], v[84:87], a[80:83], v[132:135]
    v_and_b32 v190, 0x70, v1
    v_lshlrev_b32_e64 v190, 1, v190
    v_mfma_f32_16x16x32_bf16 v[120:123], v[88:91], a[16:19], v[120:123]
    v_lshl_add_u32 v10, v191, 4, v190
    v_and_b32 v191, 0xf0, v1
    v_mfma_f32_16x16x32_bf16 v[136:139], v[88:91], a[80:83], v[136:139]
    v_add_u32 v190, 0x100, v191
    s_waitcnt lgkmcnt(0)
    v_mfma_f32_16x16x32_bf16 v[108:111], v[92:95], a[20:23], v[108:111]
    ds_read_b128 v[76:79], v0 offset:6144
    s_waitcnt vmcnt(7)
    v_max_u32_e64 v180, v172, v173
    v_mfma_f32_16x16x32_bf16 v[124:127], v[92:95], a[84:87], v[124:127]
    ds_read_b128 v[80:83], v0 offset:22528
    v_cndmask_b32 v10, v10, v190, s[16:17]
    v_mfma_f32_16x16x32_bf16 v[112:115], v[96:99], a[20:23], v[112:115]
    ds_read_b128 v[84:87], v0 offset:38912
    v_mfma_f32_16x16x32_bf16 v[128:131], v[96:99], a[84:87], v[128:131]
    ds_read_b128 v[88:91], v0 offset:55296
    v_mfma_f32_16x16x32_bf16 v[116:119], v[100:103], a[20:23], v[116:119]
    v_cmp_eq_u32 vcc, -1, v180
    s_nop 0
    s_cbranch_vccnz L_retry_36
L_retryjoin_37:
    v_mfma_f32_16x16x32_bf16 v[132:135], v[100:103], a[84:87], v[132:135]
    v_permlane16_swap_b32 v172, v173
    v_mfma_f32_16x16x32_bf16 v[120:123], v[104:107], a[20:23], v[120:123]
    v_add_f32 v172, v172, v173
    v_mov_b32 v173, v172
    v_mfma_f32_16x16x32_bf16 v[136:139], v[104:107], a[84:87], v[136:139]
    s_waitcnt vmcnt(5)
    s_barrier
    s_waitcnt lgkmcnt(0)
    v_mfma_f32_16x16x32_bf16 v[108:111], v[76:79], a[24:27], v[108:111]
    ds_read_b128 v[92:95], v0 offset:7168
    v_and_b32 v72, 0x1e0, v1
    v_mfma_f32_16x16x32_bf16 v[124:127], v[76:79], a[88:91], v[124:127]
    ds_read_b128 v[96:99], v0 offset:23552
    v_lshlrev_b32 v72, 5, v72
    v_mfma_f32_16x16x32_bf16 v[112:115], v[80:83], a[24:27], v[112:115]
    ds_read_b128 v[100:103], v0 offset:39936
    v_and_b32_e64 v73, 16, v1
    v_mfma_f32_16x16x32_bf16 v[128:131], v[80:83], a[88:91], v[128:131]
    ds_read_b128 v[104:107], v0 offset:56320
    v_lshl_add_u32 v72, v73, 3, v72
    v_mfma_f32_16x16x32_bf16 v[116:119], v[84:87], a[24:27], v[116:119]
    v_permlane32_swap_b32 v172, v173
    v_mfma_f32_16x16x32_bf16 v[132:135], v[84:87], a[88:91], v[132:135]
    v_add_f32 v172, v172, v173
    v_mul_f32 v172, s68, v172
    v_mfma_f32_16x16x32_bf16 v[120:123], v[88:91], a[24:27], v[120:123]
    v_mov_b32 v173, v172
    s_and_b32 s78, s45, 3
    v_mfma_f32_16x16x32_bf16 v[136:139], v[88:91], a[88:91], v[136:139]
    s_lshl_b32 s78, s78, 8
    s_waitcnt lgkmcnt(0)
    v_mfma_f32_16x16x32_bf16 v[108:111], v[92:95], a[28:31], v[108:111]
    ds_read_b128 v[76:79], v0 offset:8192
    s_lshl2_add_u32 s78, s73, s78
    v_mfma_f32_16x16x32_bf16 v[124:127], v[92:95], a[92:95], v[124:127]
    ds_read_b128 v[80:83], v0 offset:24576
    s_add_u32 s78, s78, s92
    v_mfma_f32_16x16x32_bf16 v[112:115], v[96:99], a[28:31], v[112:115]
    ds_read_b128 v[84:87], v0 offset:40960
    s_add_u32 s78, s78, 262144
    v_mfma_f32_16x16x32_bf16 v[128:131], v[96:99], a[92:95], v[128:131]
    ds_read_b128 v[88:91], v0 offset:57344
    s_add_u32 m0, s96, 0
    v_mfma_f32_16x16x32_bf16 v[116:119], v[100:103], a[28:31], v[116:119]
    v_permlane16_swap_b32 v172, v173
    v_mfma_f32_16x16x32_bf16 v[132:135], v[100:103], a[92:95], v[132:135]
    v_fma_f32 v173, -v172, v172, v173
    v_max_f32 v173, 0, v173
    v_mfma_f32_16x16x32_bf16 v[120:123], v[104:107], a[28:31], v[120:123]
    v_add_f32 v173, s67, v173
    s_add_u32 s86, s92, 0
    v_mfma_f32_16x16x32_bf16 v[136:139], v[104:107], a[92:95], v[136:139]
    s_waitcnt lgkmcnt(0)
    v_mfma_f32_16x16x32_bf16 v[108:111], v[76:79], a[32:35], v[108:111]
    ds_read_b128 v[92:95], v0 offset:9216
    v_mfma_f32_16x16x32_bf16 v[124:127], v[76:79], a[96:99], v[124:127]
    ds_read_b128 v[96:99], v0 offset:25600
    v_mfma_f32_16x16x32_bf16 v[112:115], v[80:83], a[32:35], v[112:115]
    ds_read_b128 v[100:103], v0 offset:41984
    v_mfma_f32_16x16x32_bf16 v[128:131], v[80:83], a[96:99], v[128:131]
    ds_read_b128 v[104:107], v0 offset:58368
    v_mfma_f32_16x16x32_bf16 v[116:119], v[84:87], a[32:35], v[116:119]
    v_rsq_f32 v174, v173
    v_mfma_f32_16x16x32_bf16 v[132:135], v[84:87], a[96:99], v[132:135]
    v_mul_f32 v175, -v172, v174
    v_cndmask_b32 v174, v174, v175, s[38:39]
    v_mfma_f32_16x16x32_bf16 v[120:123], v[88:91], a[32:35], v[120:123]
    ds_write_b32 v17, v174
    v_mfma_f32_16x16x32_bf16 v[136:139], v[88:91], a[96:99], v[136:139]
    s_waitcnt lgkmcnt(1)
    v_mfma_f32_16x16x32_bf16 v[108:111], v[92:95], a[36:39], v[108:111]
    ds_read_b128 v[76:79], v0 offset:10240
    v_mfma_f32_16x16x32_bf16 v[124:127], v[92:95], a[100:103], v[124:127]
    ds_read_b128 v[80:83], v0 offset:26624
    v_mfma_f32_16x16x32_bf16 v[112:115], v[96:99], a[36:39], v[112:115]
    ds_read_b128 v[84:87], v0 offset:43008
    v_mfma_f32_16x16x32_bf16 v[128:131], v[96:99], a[100:103], v[128:131]
    ds_read_b128 v[88:91], v0 offset:59392
    v_mfma_f32_16x16x32_bf16 v[116:119], v[100:103], a[36:39], v[116:119]
    buffer_load_dwordx4 v13, s[24:27], s86 offen offset:0 lds
    v_mfma_f32_16x16x32_bf16 v[132:135], v[100:103], a[100:103], v[132:135]
    s_add_u32 s86, s92, 3072
    v_mfma_f32_16x16x32_bf16 v[120:123], v[104:107], a[36:39], v[120:123]
    buffer_load_dwordx4 v13, s[24:27], s86 offen offset:1024 lds
    v_mfma_f32_16x16x32_bf16 v[136:139], v[104:107], a[100:103], v[136:139]
    s_waitcnt vmcnt(2)
    s_waitcnt lgkmcnt(4)
    s_barrier
    s_waitcnt lgkmcnt(0)
    v_mfma_f32_16x16x32_bf16 v[108:111], v[76:79], a[40:43], v[108:111]
    ds_read_b128 v[92:95], v0 offset:11264
    s_add_u32 s86, s92, 6144
    v_mfma_f32_16x16x32_bf16 v[124:127], v[76:79], a[104:107], v[124:127]
    ds_read_b128 v[96:99], v0 offset:27648
    ds_read_b128 v[156:159], v14 offset:256
    v_mfma_f32_16x16x32_bf16 v[112:115], v[80:83], a[40:43], v[112:115]
    ds_read_b128 v[100:103], v0 offset:44032
    ds_read_b128 v[160:163], v14 offset:320
    v_mfma_f32_16x16x32_bf16 v[128:131], v[80:83], a[104:107], v[128:131]
    ds_read_b128 v[104:107], v0 offset:60416
    ds_read_b128 v[164:167], v14 offset:384
    v_mfma_f32_16x16x32_bf16 v[116:119], v[84:87], a[40:43], v[116:119]
    buffer_load_dwordx4 v13, s[24:27], s86 offen offset:2048 lds
    v_mfma_f32_16x16x32_bf16 v[132:135], v[84:87], a[104:107], v[132:135]
    s_add_u32 s86, s92, 9216
    ds_read_b128 v[168:171], v14 offset:448
    v_mfma_f32_16x16x32_bf16 v[120:123], v[88:91], a[40:43], v[120:123]
    buffer_load_dwordx4 v13, s[24:27], s86 offen offset:3072 lds
    v_mfma_f32_16x16x32_bf16 v[136:139], v[88:91], a[104:107], v[136:139]
    ds_read_b128 v[140:143], v14 offset:0
    s_waitcnt lgkmcnt(3)
    v_mfma_f32_16x16x32_bf16 v[108:111], v[92:95], a[44:47], v[108:111]
    ds_read_b128 v[76:79], v0 offset:12288
    ds_read_b128 v[144:147], v14 offset:64
    v_mfma_f32_16x16x32_bf16 v[124:127], v[92:95], a[108:111], v[124:127]
    ds_read_b128 v[80:83], v0 offset:28672
    ds_read_b128 v[148:151], v14 offset:128
    v_mfma_f32_16x16x32_bf16 v[112:115], v[96:99], a[44:47], v[112:115]
    ds_read_b128 v[84:87], v0 offset:45056
    ds_read_b128 v[152:155], v14 offset:192
    v_mfma_f32_16x16x32_bf16 v[128:131], v[96:99], a[108:111], v[128:131]
    ds_read_b128 v[88:91], v0 offset:61440
    v_mfma_f32_16x16x32_bf16 v[116:119], v[100:103], a[44:47], v[116:119]
    s_mov_b32 exec_hi, 0
    buffer_load_dword v74, v72, s[24:27], s78 offen
    s_mov_b64 exec, -1
    v_mfma_f32_16x16x32_bf16 v[132:135], v[100:103], a[108:111], v[132:135]
    s_add_u32 m0, s97, 0
    s_add_u32 s86, s93, 0
    v_mfma_f32_16x16x32_bf16 v[120:123], v[104:107], a[44:47], v[120:123]
    buffer_load_dwordx4 v13, s[24:27], s86 offen offset:0 lds
    v_mfma_f32_16x16x32_bf16 v[136:139], v[104:107], a[108:111], v[136:139]
    s_add_u32 s86, s93, 3072
    s_waitcnt lgkmcnt(0)
    v_mfma_f32_16x16x32_bf16 v[108:111], v[76:79], a[48:51], v[108:111]
    ds_read_b128 v[92:95], v0 offset:13312
    v_fma_f32 v172, v156, v28, s65
    v_mfma_f32_16x16x32_bf16 v[124:127], v[76:79], a[112:115], v[124:127]
    ds_read_b128 v[96:99], v0 offset:29696
    v_mul_f32 v156, v156, v29
    v_mfma_f32_16x16x32_bf16 v[112:115], v[80:83], a[48:51], v[112:115]
    ds_read_b128 v[100:103], v0 offset:46080
    v_fma_f32 v173, v157, v28, s65
    v_mfma_f32_16x16x32_bf16 v[128:131], v[80:83], a[112:115], v[128:131]
    ds_read_b128 v[104:107], v0 offset:62464
    v_mul_f32_e64 v157, v157, v29
    v_mfma_f32_16x16x32_bf16 v[116:119], v[84:87], a[48:51], v[116:119]
    buffer_load_dwordx4 v13, s[24:27], s86 offen offset:1024 lds
    v_mfma_f32_16x16x32_bf16 v[132:135], v[84:87], a[112:115], v[132:135]
    s_add_u32 s86, s93, 6144
    v_fma_f32 v174, v158, v28, s65
    v_mfma_f32_16x16x32_bf16 v[120:123], v[88:91], a[48:51], v[120:123]
    buffer_load_dwordx4 v13, s[24:27], s86 offen offset:2048 lds
    v_mfma_f32_16x16x32_bf16 v[136:139], v[88:91], a[112:115], v[136:139]
    s_add_u32 s86, s93, 9216
    s_waitcnt lgkmcnt(0)
    v_mfma_f32_16x16x32_bf16 v[108:111], v[92:95], a[52:55], v[108:111]
    ds_read_b128 v[76:79], v0 offset:14336
    v_mul_f32 v158, v158, v29
    v_mfma_f32_16x16x32_bf16 v[124:127], v[92:95], a[116:119], v[124:127]
    ds_read_b128 v[80:83], v0 offset:30720
    v_fma_f32 v175, v159, v28, s65
    v_mfma_f32_16x16x32_bf16 v[112:115], v[96:99], a[52:55], v[112:115]
    ds_read_b128 v[84:87], v0 offset:47104
    v_mul_f32_e64 v159, v159, v29
    v_mfma_f32_16x16x32_bf16 v[128:131], v[96:99], a[116:119], v[128:131]
    ds_read_b128 v[88:91], v0 offset:63488
    v_fma_f32 v176, v160, v28, s65
    v_mfma_f32_16x16x32_bf16 v[116:119], v[100:103], a[52:55], v[116:119]
    buffer_load_dwordx4 v13, s[24:27], s86 offen offset:3072 lds
    v_mfma_f32_16x16x32_bf16 v[132:135], v[100:103], a[116:119], v[132:135]
    v_mul_f32 v160, v160, v29
    v_fma_f32 v177, v161, v28, s65
    v_mfma_f32_16x16x32_bf16 v[120:123], v[104:107], a[52:55], v[120:123]
    v_mul_f32 v161, v161, v29
    v_fma_f32 v178, v162, v28, s65
    v_mfma_f32_16x16x32_bf16 v[136:139], v[104:107], a[116:119], v[136:139]
    v_mul_f32 v162, v162, v29
    s_waitcnt lgkmcnt(0)
    v_mfma_f32_16x16x32_bf16 v[108:111], v[76:79], a[56:59], v[108:111]
    ds_read_b128 v[92:95], v0 offset:15360
    v_fma_f32 v179, v163, v28, s65
    v_mfma_f32_16x16x32_bf16 v[124:127], v[76:79], a[120:123], v[124:127]
    ds_read_b128 v[96:99], v0 offset:31744
    v_mul_f32_e64 v163, v163, v29
    v_mfma_f32_16x16x32_bf16 v[112:115], v[80:83], a[56:59], v[112:115]
    ds_read_b128 v[100:103], v0 offset:48128
    v_fma_f32 v180, v164, v28, s65
    v_mfma_f32_16x16x32_bf16 v[128:131], v[80:83], a[120:123], v[128:131]
    ds_read_b128 v[104:107], v0 offset:64512
    v_mul_f32 v164, v164, v29
    v_mfma_f32_16x16x32_bf16 v[116:119], v[84:87], a[56:59], v[116:119]
    v_fma_f32 v181, v165, v28, s65
    v_mul_f32 v165, v165, v29
    v_mfma_f32_16x16x32_bf16 v[132:135], v[84:87], a[120:123], v[132:135]
    v_fma_f32 v182, v166, v28, s65
    v_mul_f32 v166, v166, v29
    v_mfma_f32_16x16x32_bf16 v[120:123], v[88:91], a[56:59], v[120:123]
    v_fma_f32 v183, v167, v28, s65
    v_mul_f32 v167, v167, v29
    v_mfma_f32_16x16x32_bf16 v[136:139], v[88:91], a[120:123], v[136:139]
    v_fma_f32 v184, v168, v28, s65
    s_waitcnt lgkmcnt(0)
    v_mfma_f32_16x16x32_bf16 v[108:111], v[92:95], a[60:63], v[108:111]
    v_mul_f32 v168, v168, v29
    v_fma_f32 v185, v169, v28, s65
    v_mfma_f32_16x16x32_bf16 v[124:127], v[92:95], a[124:127], v[124:127]
    v_mul_f32 v169, v169, v29
    v_fma_f32 v186, v170, v28, s65
    v_mfma_f32_16x16x32_bf16 v[112:115], v[96:99], a[60:63], v[112:115]
    v_mul_f32 v170, v170, v29
    v_fma_f32 v187, v171, v28, s65
    v_mfma_f32_16x16x32_bf16 v[128:131], v[96:99], a[124:127], v[128:131]
    v_mul_f32_e64 v171, v171, v29
    v_mfma_f32_16x16x32_bf16 v[116:119], v[100:103], a[60:63], v[116:119]
    v_mfma_f32_16x16x32_bf16 v[132:135], v[100:103], a[124:127], v[132:135]
    v_mfma_f32_16x16x32_bf16 v[120:123], v[104:107], a[60:63], v[120:123]
    v_mfma_f32_16x16x32_bf16 v[136:139], v[104:107], a[124:127], v[136:139]
    v_pk_fma_f32 v[108:109], v[108:109], v[140:141], v[172:173]
    v_pk_fma_f32 v[110:111], v[110:111], v[142:143], v[174:175]
    v_pk_mul_f32 v[92:93], v[108:109], s[84:85]
    v_pk_mul_f32 v[94:95], v[110:111], s[84:85]
    v_pk_fma_f32 v[124:125], v[124:125], v[140:141], v[156:157]
    v_pk_fma_f32 v[126:127], v[126:127], v[142:143], v[158:159]
    v_exp_f32_e64 v92, v92 clamp
    v_exp_f32_e64 v93, v93 clamp
    v_exp_f32_e64 v94, v94 clamp
    v_exp_f32_e64 v95, v95 clamp
    v_max_f32 v108, s65, v108
    v_max_f32 v109, s65, v109
    v_max_f32 v110, s65, v110
    v_max_f32 v111, s65, v111
    v_pk_add_f32 v[108:109], v[108:109], v[92:93]
    v_pk_add_f32 v[110:111], v[110:111], v[94:95]
    v_cvt_pk_bf16_f32 v84, v124, v125
    v_cvt_pk_bf16_f32 v85, v126, v127
    v_cvt_pk_bf16_f32 v76, v108, v109
    v_cvt_pk_bf16_f32 v77, v110, v111
    v_pk_fma_f32 v[112:113], v[112:113], v[144:145], v[176:177]
    v_pk_fma_f32 v[114:115], v[114:115], v[146:147], v[178:179]
    v_pk_mul_f32 v[92:93], v[112:113], s[84:85]
    v_pk_mul_f32 v[94:95], v[114:115], s[84:85]
    v_pk_fma_f32 v[128:129], v[128:129], v[144:145], v[160:161]
    v_pk_fma_f32 v[130:131], v[130:131], v[146:147], v[162:163]
    v_exp_f32_e64 v92, v92 clamp
    v_exp_f32_e64 v93, v93 clamp
    v_exp_f32_e64 v94, v94 clamp
    v_exp_f32_e64 v95, v95 clamp
    v_max_f32 v112, s65, v112
    v_max_f32 v113, s65, v113
    v_max_f32 v114, s65, v114
    v_max_f32 v115, s65, v115
    v_pk_add_f32 v[112:113], v[112:113], v[92:93]
    v_pk_add_f32 v[114:115], v[114:115], v[94:95]
    v_cvt_pk_bf16_f32 v86, v128, v129
    v_cvt_pk_bf16_f32 v87, v130, v131
    v_cvt_pk_bf16_f32 v78, v112, v113
    v_cvt_pk_bf16_f32 v79, v114, v115
    v_pk_fma_f32 v[116:117], v[116:117], v[148:149], v[180:181]
    v_pk_fma_f32 v[118:119], v[118:119], v[150:151], v[182:183]
    v_pk_mul_f32 v[92:93], v[116:117], s[84:85]
    v_pk_mul_f32 v[94:95], v[118:119], s[84:85]
    v_pk_fma_f32 v[132:133], v[132:133], v[148:149], v[164:165]
    v_pk_fma_f32 v[134:135], v[134:135], v[150:151], v[166:167]
    v_exp_f32_e64 v92, v92 clamp
    v_exp_f32_e64 v93, v93 clamp
    v_exp_f32_e64 v94, v94 clamp
    v_exp_f32_e64 v95, v95 clamp
    v_max_f32 v116, s65, v116
    v_max_f32 v117, s65, v117
    v_max_f32 v118, s65, v118
    v_max_f32 v119, s65, v119
    v_pk_add_f32 v[116:117], v[116:117], v[92:93]
    v_pk_add_f32 v[118:119], v[118:119], v[94:95]
    v_cvt_pk_bf16_f32 v88, v132, v133
    v_cvt_pk_bf16_f32 v89, v134, v135
    v_cvt_pk_bf16_f32 v80, v116, v117
    v_cvt_pk_bf16_f32 v81, v118, v119
    v_pk_fma_f32 v[120:121], v[120:121], v[152:153], v[184:185]
    v_pk_fma_f32 v[122:123], v[122:123], v[154:155], v[186:187]
    v_pk_mul_f32 v[92:93], v[120:121], s[84:85]
    v_pk_mul_f32 v[94:95], v[122:123], s[84:85]
    v_pk_fma_f32 v[136:137], v[136:137], v[152:153], v[168:169]
    v_pk_fma_f32 v[138:139], v[138:139], v[154:155], v[170:171]
    v_exp_f32_e64 v92, v92 clamp
    v_exp_f32_e64 v93, v93 clamp
    v_exp_f32_e64 v94, v94 clamp
    v_exp_f32_e64 v95, v95 clamp
    v_max_f32 v120, s65, v120
    v_max_f32 v121, s65, v121
    v_max_f32 v122, s65, v122
    v_max_f32 v123, s65, v123
    v_pk_add_f32 v[120:121], v[120:121], v[92:93]
    v_pk_add_f32 v[122:123], v[122:123], v[94:95]
    v_cvt_pk_bf16_f32 v90, v136, v137
    v_cvt_pk_bf16_f32 v91, v138, v139
    v_cvt_pk_bf16_f32 v82, v120, v121
    v_cvt_pk_bf16_f32 v83, v122, v123
    v_mfma_f32_16x16x32_bf16 v[140:143], v[76:79], v[84:87], 0
    s_nop 0
    v_mfma_f32_16x16x32_bf16 v[140:143], v[80:83], v[88:91], v[140:143]
    v_mfma_f32_16x16x32_bf16 v[144:147], v[76:79], v[24:27], 0
    v_mfma_f32_16x16x32_bf16 v[144:147], v[80:83], v[24:27], v[144:147]
    ds_read_b32 v164, v15 offset:0
    ds_read_b32 v165, v15 offset:256
    ds_read_b32 v166, v15 offset:64
    ds_read_b32 v167, v15 offset:320
    ds_read_b32 v168, v15 offset:128
    ds_read_b32 v169, v15 offset:384
    ds_read_b32 v170, v15 offset:192
    ds_read_b32 v171, v15 offset:448
    v_cvt_pk_bf16_f32 v140, v140, v141
    v_cvt_pk_bf16_f32 v141, v142, v143
    v_min_u32 v140, -2, v140
    v_min_u32 v141, -2, v141
    buffer_store_dwordx2 v[140:141], v9, s[28:31], s77 offen sc1
    v_min_u32 v144, -2, v144
    v_min_u32 v145, -2, v145
    v_min_u32 v146, -2, v146
    v_min_u32_e64 v147, -2, v147
    s_mov_b32 exec_lo, 0x00010001
    s_mov_b32 exec_hi, 0x00010001
    buffer_store_dwordx4 v[144:147], v16, s[28:31], s8 offen sc1
    s_mov_b64 exec, -1
    ds_read_b128 v[76:79], v0 offset:0
    ds_read_b128 v[80:83], v0 offset:16384
    ds_read_b128 v[84:87], v0 offset:32768
    ds_read_b128 v[88:91], v0 offset:49152
    ds_read_b128 v[92:95], v0 offset:1024
    ds_read_b128 v[96:99], v0 offset:17408
    ds_read_b128 v[100:103], v0 offset:33792
    ds_read_b128 v[104:107], v0 offset:50176
    s_waitcnt lgkmcnt(6)
    v_mfma_f32_16x16x32_bf16 v[124:127], a[128:131], v[76:79], 0
    ds_read_b128 v[108:111], v0 offset:2048
    s_add_u32 m0, s98, 0
    s_add_u32 s86, s94, 0
    buffer_load_dwordx4 v13, s[24:27], s86 offen offset:0 lds
    v_mfma_f32_16x16x32_bf16 v[128:131], a[128:131], v[80:83], 0
    ds_read_b128 v[112:115], v0 offset:18432
    s_waitcnt lgkmcnt(6)
    v_mfma_f32_16x16x32_bf16 v[132:135], a[128:131], v[84:87], 0
    ds_read_b128 v[116:119], v0 offset:34816
    v_fma_f32 v172, v165, v30, s65
    v_mfma_f32_16x16x32_bf16 v[136:139], a[128:131], v[88:91], 0
    ds_read_b128 v[120:123], v0 offset:51200
    s_waitcnt lgkmcnt(6)
    v_mfma_f32_16x16x32_bf16 v[124:127], a[132:135], v[92:95], v[124:127]
    ds_read_b128 v[76:79], v0 offset:3072
    v_fma_f32 v173, v165, v31, s65
    v_mfma_f32_16x16x32_bf16 v[128:131], a[132:135], v[96:99], v[128:131]
    ds_read_b128 v[80:83], v0 offset:19456
    s_add_u32 s86, s94, 3072
    buffer_load_dwordx4 v13, s[24:27], s86 offen offset:1024 lds
    s_waitcnt lgkmcnt(6)
    v_mfma_f32_16x16x32_bf16 v[132:135], a[132:135], v[100:103], v[132:135]
    ds_read_b128 v[84:87], v0 offset:35840
    v_fma_f32 v174, v165, v32, s65
    v_mfma_f32_16x16x32_bf16 v[136:139], a[132:135], v[104:107], v[136:139]
    ds_read_b128 v[88:91], v0 offset:52224
    s_waitcnt lgkmcnt(6)
    v_mfma_f32_16x16x32_bf16 v[124:127], a[136:139], v[108:111], v[124:127]
    ds_read_b128 v[92:95], v0 offset:4096
    v_fma_f32 v175, v165, v33, s65
    v_mfma_f32_16x16x32_bf16 v[128:131], a[136:139], v[112:115], v[128:131]
    ds_read_b128 v[96:99], v0 offset:20480
    s_waitcnt lgkmcnt(6)
    v_mfma_f32_16x16x32_bf16 v[132:135], a[136:139], v[116:119], v[132:135]
    ds_read_b128 v[100:103], v0 offset:36864
    s_add_u32 s86, s94, 6144
    buffer_load_dwordx4 v13, s[24:27], s86 offen offset:2048 lds
    v_mfma_f32_16x16x32_bf16 v[136:139], a[136:139], v[120:123], v[136:139]
    ds_read_b128 v[104:107], v0 offset:53248
    s_waitcnt lgkmcnt(6)
    v_mfma_f32_16x16x32_bf16 v[124:127], a[140:143], v[76:79], v[124:127]
    ds_read_b128 v[108:111], v0 offset:5120
    v_fma_f32 v176, v167, v30, s65
    v_mfma_f32_16x16x32_bf16 v[128:131], a[140:143], v[80:83], v[128:131]
    ds_read_b128 v[112:115], v0 offset:21504
    s_waitcnt lgkmcnt(6)
    v_mfma_f32_16x16x32_bf16 v[132:135], a[140:143], v[84:87], v[132:135]
    ds_read_b128 v[116:119], v0 offset:37888
    v_fma_f32 v177, v167, v31, s65
    v_mfma_f32_16x16x32_bf16 v[136:139], a[140:143], v[88:91], v[136:139]
    ds_read_b128 v[120:123], v0 offset:54272
    s_add_u32 s86, s94, 9216
    buffer_load_dwordx4 v13, s[24:27], s86 offen offset:3072 lds
    s_waitcnt lgkmcnt(6)
    v_mfma_f32_16x16x32_bf16 v[124:127], a[144:147], v[92:95], v[124:127]
    ds_read_b128 v[76:79], v0 offset:6144
    v_fma_f32 v178, v167, v32, s65
    v_mfma_f32_16x16x32_bf16 v[128:131], a[144:147], v[96:99], v[128:131]
    ds_read_b128 v[80:83], v0 offset:22528
    s_waitcnt lgkmcnt(6)
    v_mfma_f32_16x16x32_bf16 v[132:135], a[144:147], v[100:103], v[132:135]
    ds_read_b128 v[84:87], v0 offset:38912
    v_fma_f32 v179, v167, v33, s65
    v_mfma_f32_16x16x32_bf16 v[136:139], a[144:147], v[104:107], v[136:139]
    ds_read_b128 v[88:91], v0 offset:55296
    s_waitcnt lgkmcnt(6)
    v_mfma_f32_16x16x32_bf16 v[124:127], a[148:151], v[108:111], v[124:127]
    ds_read_b128 v[92:95], v0 offset:7168
    s_add_u32 m0, s99, 0
    s_add_u32 s86, s95, 0
    buffer_load_dwordx4 v13, s[24:27], s86 offen offset:0 lds
    v_mfma_f32_16x16x32_bf16 v[128:131], a[148:151], v[112:115], v[128:131]
    ds_read_b128 v[96:99], v0 offset:23552
    s_waitcnt lgkmcnt(6)
    v_mfma_f32_16x16x32_bf16 v[132:135], a[148:151], v[116:119], v[132:135]
    ds_read_b128 v[100:103], v0 offset:39936
    v_fma_f32 v180, v169, v30, s65
    v_mfma_f32_16x16x32_bf16 v[136:139], a[148:151], v[120:123], v[136:139]
    ds_read_b128 v[104:107], v0 offset:56320
    s_waitcnt lgkmcnt(6)
    v_mfma_f32_16x16x32_bf16 v[124:127], a[152:155], v[76:79], v[124:127]
    ds_read_b128 v[108:111], v0 offset:8192
    v_fma_f32 v181, v169, v31, s65
    v_mfma_f32_16x16x32_bf16 v[128:131], a[152:155], v[80:83], v[128:131]
    ds_read_b128 v[112:115], v0 offset:24576
    s_add_u32 s86, s95, 3072
    buffer_load_dwordx4 v13, s[24:27], s86 offen offset:1024 lds
    s_waitcnt lgkmcnt(6)
    v_mfma_f32_16x16x32_bf16 v[132:135], a[152:155], v[84:87], v[132:135]
    ds_read_b128 v[116:119], v0 offset:40960
    v_fma_f32 v182, v169, v32, s65
    v_mfma_f32_16x16x32_bf16 v[136:139], a[152:155], v[88:91], v[136:139]
    ds_read_b128 v[120:123], v0 offset:57344
    s_waitcnt lgkmcnt(6)
    v_mfma_f32_16x16x32_bf16 v[124:127], a[156:159], v[92:95], v[124:127]
    ds_read_b128 v[76:79], v0 offset:9216
    v_fma_f32 v183, v169, v33, s65
    v_mfma_f32_16x16x32_bf16 v[128:131], a[156:159], v[96:99], v[128:131]
    ds_read_b128 v[80:83], v0 offset:25600
    s_waitcnt lgkmcnt(6)
    v_mfma_f32_16x16x32_bf16 v[132:135], a[156:159], v[100:103], v[132:135]
    ds_read_b128 v[84:87], v0 offset:41984
    s_add_u32 s86, s95, 6144
    buffer_load_dwordx4 v13, s[24:27], s86 offen offset:2048 lds
    v_mfma_f32_16x16x32_bf16 v[136:139], a[156:159], v[104:107], v[136:139]
    ds_read_b128 v[88:91], v0 offset:58368
    s_waitcnt lgkmcnt(6)
    v_mfma_f32_16x16x32_bf16 v[124:127], a[160:163], v[108:111], v[124:127]
    ds_read_b128 v[92:95], v0 offset:10240
    v_fma_f32 v184, v171, v30, s65
    v_mfma_f32_16x16x32_bf16 v[128:131], a[160:163], v[112:115], v[128:131]
    ds_read_b128 v[96:99], v0 offset:26624
    s_waitcnt lgkmcnt(6)
    v_mfma_f32_16x16x32_bf16 v[132:135], a[160:163], v[116:119], v[132:135]
    ds_read_b128 v[100:103], v0 offset:43008
    v_fma_f32 v185, v171, v31, s65
    v_mfma_f32_16x16x32_bf16 v[136:139], a[160:163], v[120:123], v[136:139]
    ds_read_b128 v[104:107], v0 offset:59392
    s_add_u32 s86, s95, 9216
    buffer_load_dwordx4 v13, s[24:27], s86 offen offset:3072 lds
    s_waitcnt lgkmcnt(6)
    v_mfma_f32_16x16x32_bf16 v[124:127], a[164:167], v[76:79], v[124:127]
    ds_read_b128 v[108:111], v0 offset:11264
    v_fma_f32 v186, v171, v32, s65
    v_mfma_f32_16x16x32_bf16 v[128:131], a[164:167], v[80:83], v[128:131]
    ds_read_b128 v[112:115], v0 offset:27648
    s_waitcnt lgkmcnt(6)
    v_mfma_f32_16x16x32_bf16 v[132:135], a[164:167], v[84:87], v[132:135]
    ds_read_b128 v[116:119], v0 offset:44032
    v_fma_f32 v187, v171, v33, s65
    v_mfma_f32_16x16x32_bf16 v[136:139], a[164:167], v[88:91], v[136:139]
    ds_read_b128 v[120:123], v0 offset:60416
    s_waitcnt lgkmcnt(6)
    v_mfma_f32_16x16x32_bf16 v[124:127], a[168:171], v[92:95], v[124:127]
    ds_read_b128 v[76:79], v0 offset:12288
    v_and_b32 v190, 16, v1
    v_mfma_f32_16x16x32_bf16 v[128:131], a[168:171], v[96:99], v[128:131]
    ds_read_b128 v[80:83], v0 offset:28672
    s_waitcnt lgkmcnt(6)
    v_mfma_f32_16x16x32_bf16 v[132:135], a[168:171], v[100:103], v[132:135]
    ds_read_b128 v[84:87], v0 offset:45056
    v_mov_b32 v11, 0x3f80
    v_mfma_f32_16x16x32_bf16 v[136:139], a[168:171], v[104:107], v[136:139]
    ds_read_b128 v[88:91], v0 offset:61440
    s_waitcnt lgkmcnt(6)
    v_mfma_f32_16x16x32_bf16 v[124:127], a[172:175], v[108:111], v[124:127]
    ds_read_b128 v[92:95], v0 offset:13312
    v_lshlrev_b32 v190, v190, v11
    v_mfma_f32_16x16x32_bf16 v[128:131], a[172:175], v[112:115], v[128:131]
    ds_read_b128 v[96:99], v0 offset:29696
    s_waitcnt lgkmcnt(6)
    v_mfma_f32_16x16x32_bf16 v[132:135], a[172:175], v[116:119], v[132:135]
    ds_read_b128 v[100:103], v0 offset:46080
    v_bfe_u32 v11, v1, 5, 2
    v_mfma_f32_16x16x32_bf16 v[136:139], a[172:175], v[120:123], v[136:139]
    ds_read_b128 v[104:107], v0 offset:62464
    s_waitcnt lgkmcnt(6)
    v_mfma_f32_16x16x32_bf16 v[124:127], a[176:179], v[76:79], v[124:127]
    ds_read_b128 v[108:111], v0 offset:14336
    buffer_load_dwordx4 v[140:143], v1, s[28:31], s9 offen offset:0 sc1
    v_mfma_f32_16x16x32_bf16 v[128:131], a[176:179], v[80:83], v[128:131]
    ds_read_b128 v[112:115], v0 offset:30720
    s_waitcnt lgkmcnt(6)
    v_mfma_f32_16x16x32_bf16 v[132:135], a[176:179], v[84:87], v[132:135]
    ds_read_b128 v[116:119], v0 offset:47104
    buffer_load_dwordx4 v[144:147], v1, s[28:31], s9 offen offset:1024 sc1
    v_mfma_f32_16x16x32_bf16 v[136:139], a[176:179], v[88:91], v[136:139]
    ds_read_b128 v[120:123], v0 offset:63488
    s_waitcnt lgkmcnt(6)
    v_mfma_f32_16x16x32_bf16 v[124:127], a[180:183], v[92:95], v[124:127]
    ds_read_b128 v[76:79], v0 offset:15360
    buffer_load_dwordx4 v[148:151], v1, s[28:31], s9 offen offset:2048 sc1
    v_mfma_f32_16x16x32_bf16 v[128:131], a[180:183], v[96:99], v[128:131]
    ds_read_b128 v[80:83], v0 offset:31744
    s_waitcnt lgkmcnt(6)
    v_mfma_f32_16x16x32_bf16 v[132:135], a[180:183], v[100:103], v[132:135]
    ds_read_b128 v[84:87], v0 offset:48128
    buffer_load_dwordx4 v[152:155], v1, s[28:31], s9 offen offset:3072 sc1
    v_mfma_f32_16x16x32_bf16 v[136:139], a[180:183], v[104:107], v[136:139]
    ds_read_b128 v[88:91], v0 offset:64512
    s_waitcnt lgkmcnt(6)
    v_mfma_f32_16x16x32_bf16 v[124:127], a[184:187], v[108:111], v[124:127]
    buffer_load_dwordx4 v[156:159], v191, s[28:31], s10 offen offset:0 sc1
    v_mfma_f32_16x16x32_bf16 v[128:131], a[184:187], v[112:115], v[128:131]
    s_waitcnt lgkmcnt(4)
    v_mfma_f32_16x16x32_bf16 v[132:135], a[184:187], v[116:119], v[132:135]
    buffer_load_dwordx4 v[160:163], v191, s[28:31], s10 offen offset:256 sc1
    v_mfma_f32_16x16x32_bf16 v[136:139], a[184:187], v[120:123], v[136:139]
    s_waitcnt lgkmcnt(2)
    v_mfma_f32_16x16x32_bf16 v[124:127], a[188:191], v[76:79], v[124:127]
    v_cmp_eq_u32 vcc, 0, v11
    s_nop 1
    v_cndmask_b32 v20, 0, v190, vcc
    v_mfma_f32_16x16x32_bf16 v[128:131], a[188:191], v[80:83], v[128:131]
    s_waitcnt lgkmcnt(0)
    v_mfma_f32_16x16x32_bf16 v[132:135], a[188:191], v[84:87], v[132:135]
    v_cmp_eq_u32 vcc, 1, v11
    s_nop 1
    v_cndmask_b32 v21, 0, v190, vcc
    v_mfma_f32_16x16x32_bf16 v[136:139], a[188:191], v[88:91], v[136:139]
    v_cmp_eq_u32 vcc, 2, v11
    s_nop 1
    v_cndmask_b32 v22, 0, v190, vcc
    v_cmp_eq_u32 vcc, 3, v11
    s_nop 1
    v_cndmask_b32 v23, 0, v190, vcc
    s_add_u32 s76, s51, 0x40000
    s_add_u32 s11, s11, s76
    s_lshl_b32 s14, s46, 12
    s_add_u32 s12, s14, s76
    s_add_u32 s13, s12, 0x4000
    s_lshl_b32 s76, s87, 16
    s_add_u32 s14, s14, s76
    s_add_u32 s14, s14, 0x200000
    s_add_u32 s15, s14, 0x4000
    s_add_u32 s19, s51, 0x52000
    v_bfe_u32 v190, v1, 6, 2
    v_xor_b32 v11, s46, v190
    v_lshlrev_b32 v11, 6, v11
    v_lshl_add_u32 v11, v190, 8, v11
    v_and_b32 v190, 0x210, v1
    v_lshl_add_u32 v11, v190, 1, v11
    v_bfe_u32 v190, v1, 8, 1
    v_lshl_add_u32 v11, v190, 4, v11
    v_bfe_u32 v190, v1, 5, 1
    v_lshl_add_u32 v11, v190, 3, v11
    v_pk_fma_f32 v[124:125], v[124:125], v[164:165], v[172:173] op_sel_hi:[1,0,1]
    v_pk_fma_f32 v[126:127], v[126:127], v[164:165], v[174:175] op_sel_hi:[1,0,1]
    v_pk_mul_f32 v[76:77], v[124:125], s[84:85]
    v_pk_mul_f32 v[78:79], v[126:127], s[84:85]
    v_exp_f32_e64 v76, v76 clamp
    v_exp_f32_e64 v77, v77 clamp
    v_exp_f32_e64 v78, v78 clamp
    v_exp_f32_e64 v79, v79 clamp
    v_max_f32 v124, s65, v124
    v_max_f32 v125, s65, v125
    v_max_f32 v126, s65, v126
    v_max_f32 v127, s65, v127
    v_pk_add_f32 v[124:125], v[124:125], v[76:77]
    v_pk_add_f32 v[126:127], v[126:127], v[78:79]
    v_cvt_pk_bf16_f32 v84, v124, v125
    v_cvt_pk_bf16_f32 v85, v126, v127
    v_pk_fma_f32 v[128:129], v[128:129], v[166:167], v[176:177] op_sel_hi:[1,0,1]
    v_pk_fma_f32 v[130:131], v[130:131], v[166:167], v[178:179] op_sel_hi:[1,0,1]
    v_pk_mul_f32 v[76:77], v[128:129], s[84:85]
    v_pk_mul_f32 v[78:79], v[130:131], s[84:85]
    v_exp_f32_e64 v76, v76 clamp
    v_exp_f32_e64 v77, v77 clamp
    v_exp_f32_e64 v78, v78 clamp
    v_exp_f32_e64 v79, v79 clamp
    v_max_f32 v128, s65, v128
    v_max_f32 v129, s65, v129
    v_max_f32 v130, s65, v130
    v_max_f32 v131, s65, v131
    v_pk_add_f32 v[128:129], v[128:129], v[76:77]
    v_pk_add_f32 v[130:131], v[130:131], v[78:79]
    v_cvt_pk_bf16_f32 v86, v128, v129
    v_cvt_pk_bf16_f32 v87, v130, v131
    s_cmp_eq_u32 s48, 0
    s_cbranch_scc1 L_slowst_39
    buffer_store_dwordx2 v[84:85], v8, s[28:31], s36 offen offset:0
    buffer_store_dwordx2 v[86:87], v8, s[28:31], s36 offen offset:256
L_joinst_40:
    v_pk_fma_f32 v[132:133], v[132:133], v[168:169], v[180:181] op_sel_hi:[1,0,1]
    v_pk_fma_f32 v[134:135], v[134:135], v[168:169], v[182:183] op_sel_hi:[1,0,1]
    v_pk_mul_f32 v[76:77], v[132:133], s[84:85]
    v_pk_mul_f32 v[78:79], v[134:135], s[84:85]
    v_exp_f32_e64 v76, v76 clamp
    v_exp_f32_e64 v77, v77 clamp
    v_exp_f32_e64 v78, v78 clamp
    v_exp_f32_e64 v79, v79 clamp
    v_max_f32 v132, s65, v132
    v_max_f32 v133, s65, v133
    v_max_f32 v134, s65, v134
    v_max_f32 v135, s65, v135
    v_pk_add_f32 v[132:133], v[132:133], v[76:77]
    v_pk_add_f32 v[134:135], v[134:135], v[78:79]
    v_cvt_pk_bf16_f32 v88, v132, v133
    v_cvt_pk_bf16_f32 v89, v134, v135
    v_pk_fma_f32 v[136:137], v[136:137], v[170:171], v[184:185] op_sel_hi:[1,0,1]
    v_pk_fma_f32 v[138:139], v[138:139], v[170:171], v[186:187] op_sel_hi:[1,0,1]
    v_pk_mul_f32 v[76:77], v[136:137], s[84:85]
    v_pk_mul_f32 v[78:79], v[138:139], s[84:85]
    v_exp_f32_e64 v76, v76 clamp
    v_exp_f32_e64 v77, v77 clamp
    v_exp_f32_e64 v78, v78 clamp
    v_exp_f32_e64 v79, v79 clamp
    v_max_f32 v136, s65, v136
    v_max_f32 v137, s65, v137
    v_max_f32 v138, s65, v138
    v_max_f32 v139, s65, v139
    v_pk_add_f32 v[136:137], v[136:137], v[76:77]
    v_pk_add_f32 v[138:139], v[138:139], v[78:79]
    v_cvt_pk_bf16_f32 v90, v136, v137
    v_cvt_pk_bf16_f32 v91, v138, v139
    s_cmp_eq_u32 s48, 0
    s_cbranch_scc1 L_slowst_41
    buffer_store_dwordx2 v[88:89], v8, s[28:31], s37 offen offset:0
    buffer_store_dwordx2 v[90:91], v8, s[28:31], s37 offen offset:256
L_joinst_42:
    s_waitcnt vmcnt(10)
    s_barrier
    s_add_u32 m0, s96, 65536
    s_add_u32 s86, s92, 262144
    buffer_load_dwordx4 v13, s[24:27], s86 offen offset:0 lds
    s_add_u32 s86, s92, 265216
    buffer_load_dwordx4 v13, s[24:27], s86 offen offset:1024 lds
    s_add_u32 s86, s92, 268288
    buffer_load_dwordx4 v13, s[24:27], s86 offen offset:2048 lds
    s_add_u32 s86, s92, 271360
    buffer_load_dwordx4 v13, s[24:27], s86 offen offset:3072 lds
    s_add_u32 m0, s97, 65536
    s_add_u32 s86, s93, 262144
    buffer_load_dwordx4 v13, s[24:27], s86 offen offset:0 lds
    s_add_u32 s86, s93, 265216
    buffer_load_dwordx4 v13, s[24:27], s86 offen offset:1024 lds
    s_add_u32 s86, s93, 268288
    buffer_load_dwordx4 v13, s[24:27], s86 offen offset:2048 lds
    s_add_u32 s86, s93, 271360
    buffer_load_dwordx4 v13, s[24:27], s86 offen offset:3072 lds
    s_waitcnt vmcnt(17)
    v_max3_u32 v168, v140, v141, v142
    s_waitcnt vmcnt(16)
    v_max3_u32 v168, v168, v143, v144
    v_max3_u32 v168, v168, v145, v146
    s_waitcnt vmcnt(15)
    v_max3_u32 v168, v168, v147, v148
    v_max3_u32 v168, v168, v149, v150
    s_waitcnt vmcnt(14)
    v_max3_u32 v168, v168, v151, v152
    v_max3_u32 v168, v168, v153, v154
    s_waitcnt vmcnt(13)
    v_max3_u32 v168, v168, v155, v156
    v_max3_u32 v168, v168, v157, v158
    s_waitcnt vmcnt(12)
    v_max3_u32 v168, v168, v159, v160
    v_max3_u32 v168, v168, v161, v162
    v_max_u32_e64 v168, v168, v163
    v_cmp_eq_u32 vcc, -1, v168
    s_nop 0
    s_cbranch_vccz L_latedone_44
    s_mov_b32 s50, s49
L_late_43:
    buffer_load_dwordx4 v[140:143], v1, s[28:31], s9 offen offset:0 sc1
    buffer_load_dwordx4 v[144:147], v1, s[28:31], s9 offen offset:1024 sc1
    buffer_load_dwordx4 v[148:151], v1, s[28:31], s9 offen offset:2048 sc1
    buffer_load_dwordx4 v[152:155], v1, s[28:31], s9 offen offset:3072 sc1
    buffer_load_dwordx4 v[156:159], v191, s[28:31], s10 offen offset:0 sc1
    buffer_load_dwordx4 v[160:163], v191, s[28:31], s10 offen offset:256 sc1
    s_waitcnt vmcnt(5)
    v_max3_u32 v168, v140, v141, v142
    s_waitcnt vmcnt(4)
    v_max3_u32 v168, v168, v143, v144
    v_max3_u32 v168, v168, v145, v146
    s_waitcnt vmcnt(3)
    v_max3_u32 v168, v168, v147, v148
    v_max3_u32 v168, v168, v149, v150
    s_waitcnt vmcnt(2)
    v_max3_u32 v168, v168, v151, v152
    v_max3_u32 v168, v168, v153, v154
    s_waitcnt vmcnt(1)
    v_max3_u32 v168, v168, v155, v156
    v_max3_u32 v168, v168, v157, v158
    s_waitcnt vmcnt(0)
    v_max3_u32 v168, v168, v159, v160
    v_max3_u32 v168, v168, v161, v162
    v_max_u32 v168, v168, v163
    v_cmp_eq_u32 vcc, -1, v168
    s_nop 0
    s_cbranch_vccz L_latedone_44
    s_sub_u32 s50, s50, 1
    s_cbranch_scc0 L_late_43
    s_mov_b32 s49, 0
    s_or_b32 s72, s72, 32
L_latedone_44:
    v_pk_add_f32 v[156:157], v[156:157], v[160:161]
    v_pk_add_f32 v[158:159], v[158:159], v[162:163]
    v_mfma_f32_16x16x32_bf16 v[164:167], v[20:23], v[140:143], 0
    v_add_f32_dpp v156, v156, v156 row_ror:8 row_mask:0xf bank_mask:0xf
    v_add_f32_dpp v157, v157, v157 row_ror:8 row_mask:0xf bank_mask:0xf
    v_add_f32_dpp v158, v158, v158 row_ror:8 row_mask:0xf bank_mask:0xf
    v_add_f32_dpp v159, v159, v159 row_ror:8 row_mask:0xf bank_mask:0xf
    v_mfma_f32_16x16x32_bf16 v[164:167], v[20:23], v[144:147], v[164:167]
    v_add_f32_dpp v156, v156, v156 row_ror:4 row_mask:0xf bank_mask:0xf
    v_add_f32_dpp v157, v157, v157 row_ror:4 row_mask:0xf bank_mask:0xf
    v_add_f32_dpp v158, v158, v158 row_ror:4 row_mask:0xf bank_mask:0xf
    v_add_f32_dpp v159, v159, v159 row_ror:4 row_mask:0xf bank_mask:0xf
    v_mfma_f32_16x16x32_bf16 v[164:167], v[20:23], v[148:151], v[164:167]
    v_add_f32_dpp v156, v156, v156 row_ror:2 row_mask:0xf bank_mask:0xf
    v_add_f32_dpp v157, v157, v157 row_ror:2 row_mask:0xf bank_mask:0xf
    v_add_f32_dpp v158, v158, v158 row_ror:2 row_mask:0xf bank_mask:0xf
    v_add_f32_dpp v159, v159, v159 row_ror:2 row_mask:0xf bank_mask:0xf
    v_mfma_f32_16x16x32_bf16 v[164:167], v[20:23], v[152:155], v[164:167]
    v_add_f32_dpp v156, v156, v156 row_ror:1 row_mask:0xf bank_mask:0xf
    v_add_f32_dpp v157, v157, v157 row_ror:1 row_mask:0xf bank_mask:0xf
    v_add_f32_dpp v158, v158, v158 row_ror:1 row_mask:0xf bank_mask:0xf
    v_add_f32_dpp v159, v159, v159 row_ror:1 row_mask:0xf bank_mask:0xf
    v_cvt_pk_bf16_f32 v156, v156, v157
    v_cvt_pk_bf16_f32 v157, v158, v159
    s_nop 1
    v_add_f32_dpp v164, v164, v164 row_ror:8 row_mask:0xf bank_mask:0xf
    v_add_f32_dpp v165, v165, v165 row_ror:8 row_mask:0xf bank_mask:0xf
    v_add_f32_dpp v166, v166, v166 row_ror:8 row_mask:0xf bank_mask:0xf
    v_add_f32_dpp v167, v167, v167 row_ror:8 row_mask:0xf bank_mask:0xf
    v_cvt_pk_bf16_f32 v164, v164, v165
    v_cvt_pk_bf16_f32 v165, v166, v167
    v_cndmask_b32 v164, v164, v156, s[16:17]
    v_cndmask_b32 v165, v165, v157, s[16:17]
    v_min_u32 v164, -2, v164
    v_min_u32_e64 v165, -2, v165
    s_cmp_eq_u32 s48, 0
    s_cbranch_scc1 L_slowst_46
    s_mov_b32 exec_lo, 0x00ff00ff
    s_mov_b32 exec_hi, 0x0000ffff
    buffer_store_dwordx2 v[164:165], v10, s[28:31], s11 offen
    s_mov_b64 exec, -1
L_joinst_47:
    buffer_load_dwordx4 v[76:79], v1, s[28:31], s14 offen offset:0 sc1
    buffer_load_dwordx4 v[80:83], v1, s[28:31], s14 offen offset:1024 sc1
    buffer_load_dwordx4 v[84:87], v1, s[28:31], s14 offen offset:2048 sc1
    buffer_load_dwordx4 v[88:91], v1, s[28:31], s14 offen offset:3072 sc1
    s_waitcnt vmcnt(4)
    buffer_load_dwordx4 v[108:111], v1, s[28:31], s12 offen offset:0 sc1
    buffer_load_dwordx4 v[112:115], v1, s[28:31], s12 offen offset:1024 sc1
    buffer_load_dwordx4 v[116:119], v1, s[28:31], s12 offen offset:2048 sc1
    buffer_load_dwordx4 v[120:123], v1, s[28:31], s12 offen offset:3072 sc1
    s_lshl_b32 s52, s46, 12
    v_add_u32 v185, 0x20000, v1
    v_add_u32 v184, s52, v185
    s_add_u32 s53, s52, 0x1000
    s_and_b32 s53, s53, 0x3fff
    v_add_u32 v180, s53, v185
    s_add_u32 s53, s52, 0x2000
    s_and_b32 s53, s53, 0x3fff
    v_add_u32 v181, s53, v185
    s_add_u32 s53, s52, 0x3000
    s_and_b32 s53, s53, 0x3fff
    v_add_u32 v182, s53, v185
    s_add_u32 s52, s46, 0
    s_and_b32 s52, s52, 3
    s_lshl_b32 s52, s52, 14
    v_add_u32_e64 v190, s52, v11
    ds_read_b64_tr_b16 a[192:193], v190 offset:0
    ds_read_b64_tr_b16 a[194:195], v190 offset:2048
    ds_read_b64_tr_b16 a[196:197], v190 offset:4096
    ds_read_b64_tr_b16 a[198:199], v190 offset:6144
    ds_read_b64_tr_b16 a[200:201], v190 offset:8192
    ds_read_b64_tr_b16 a[202:203], v190 offset:10240
    ds_read_b64_tr_b16 a[204:205], v190 offset:12288
    ds_read_b64_tr_b16 a[206:207], v190 offset:14336
    s_add_u32 s52, s46, 1
    s_and_b32 s52, s52, 3
    s_lshl_b32 s52, s52, 14
    v_add_u32 v190, s52, v11
    ds_read_b64_tr_b16 a[208:209], v190 offset:0
    ds_read_b64_tr_b16 a[210:211], v190 offset:2048
    ds_read_b64_tr_b16 a[212:213], v190 offset:4096
    ds_read_b64_tr_b16 a[214:215], v190 offset:6144
    ds_read_b64_tr_b16 a[216:217], v190 offset:8192
    ds_read_b64_tr_b16 a[218:219], v190 offset:10240
    ds_read_b64_tr_b16 a[220:221], v190 offset:12288
    ds_read_b64_tr_b16 a[222:223], v190 offset:14336
    s_add_u32 s52, s46, 2
    s_and_b32 s52, s52, 3
    s_lshl_b32 s52, s52, 14
    v_add_u32 v190, s52, v11
    ds_read_b64_tr_b16 a[224:225], v190 offset:0
    ds_read_b64_tr_b16 a[226:227], v190 offset:2048
    ds_read_b64_tr_b16 a[228:229], v190 offset:4096
    ds_read_b64_tr_b16 a[230:231], v190 offset:6144
    ds_read_b64_tr_b16 a[232:233], v190 offset:8192
    ds_read_b64_tr_b16 a[234:235], v190 offset:10240
    ds_read_b64_tr_b16 a[236:237], v190 offset:12288
    ds_read_b64_tr_b16 a[238:239], v190 offset:14336
    s_add_u32 s52, s46, 3
    s_and_b32 s52, s52, 3
    s_lshl_b32 s52, s52, 14
    v_add_u32 v190, s52, v11
    ds_read_b64_tr_b16 a[240:241], v190 offset:0
    ds_read_b64_tr_b16 a[242:243], v190 offset:2048
    ds_read_b64_tr_b16 a[244:245], v190 offset:4096
    ds_read_b64_tr_b16 a[246:247], v190 offset:6144
    ds_read_b64_tr_b16 a[248:249], v190 offset:8192
    ds_read_b64_tr_b16 a[250:251], v190 offset:10240
    ds_read_b64_tr_b16 a[252:253], v190 offset:12288
    ds_read_b64_tr_b16 a[254:255], v190 offset:14336
    s_waitcnt vmcnt(6)
    v_or3_b32 v187, v77, v79, v81
    s_waitcnt vmcnt(5)
    v_or3_b32 v187, v187, v83, v85
    s_waitcnt vmcnt(4)
    v_or3_b32 v187, v187, v87, v89
    v_or_b32 v187, v187, v91
    v_ashrrev_i32 v187, 31, v187
    s_waitcnt vmcnt(3)
    v_max3_u32 v186, v187, v108, v110
    s_waitcnt vmcnt(2)
    v_max3_u32 v186, v186, v112, v114
    s_waitcnt vmcnt(1)
    v_max3_u32 v186, v186, v116, v118
    s_waitcnt vmcnt(0)
    v_max3_u32 v186, v186, v120, v122
    v_cmp_eq_u32 vcc, -1, v186
    s_nop 0
    s_cbranch_vccz L_latedone_49
    s_mov_b32 s50, s49
L_late_48:
    buffer_load_dwordx4 v[76:79], v1, s[28:31], s14 offen offset:0 sc1
    buffer_load_dwordx4 v[80:83], v1, s[28:31], s14 offen offset:1024 sc1
    buffer_load_dwordx4 v[84:87], v1, s[28:31], s14 offen offset:2048 sc1
    buffer_load_dwordx4 v[88:91], v1, s[28:31], s14 offen offset:3072 sc1
    buffer_load_dwordx4 v[108:111], v1, s[28:31], s12 offen offset:0 sc1
    buffer_load_dwordx4 v[112:115], v1, s[28:31], s12 offen offset:1024 sc1
    buffer_load_dwordx4 v[116:119], v1, s[28:31], s12 offen offset:2048 sc1
    buffer_load_dwordx4 v[120:123], v1, s[28:31], s12 offen offset:3072 sc1
    s_waitcnt vmcnt(6)
    v_or3_b32 v187, v77, v79, v81
    s_waitcnt vmcnt(5)
    v_or3_b32 v187, v187, v83, v85
    s_waitcnt vmcnt(4)
    v_or3_b32 v187, v187, v87, v89
    v_or_b32 v187, v187, v91
    v_ashrrev_i32 v187, 31, v187
    s_waitcnt vmcnt(3)
    v_max3_u32 v186, v187, v108, v110
    s_waitcnt vmcnt(2)
    v_max3_u32 v186, v186, v112, v114
    s_waitcnt vmcnt(1)
    v_max3_u32 v186, v186, v116, v118
    s_waitcnt vmcnt(0)
    v_max3_u32 v186, v186, v120, v122
    v_cmp_eq_u32 vcc, -1, v186
    s_nop 0
    s_cbranch_vccz L_latedone_49
    s_sub_u32 s50, s50, 1
    s_cbranch_scc0 L_late_48
    s_mov_b32 s49, 0
    s_or_b32 s72, s72, 256
L_latedone_49:
    v_mfma_f32_32x32x16_bf16 v[140:155], v[108:111], v[76:79], 0
    v_mfma_f32_32x32x16_bf16 v[156:171], v[112:115], v[80:83], 0
    buffer_load_dwordx4 v[92:95], v1, s[28:31], s15 offen offset:0 sc1
    buffer_load_dwordx4 v[96:99], v1, s[28:31], s15 offen offset:1024 sc1
    buffer_load_dwordx4 v[100:103], v1, s[28:31], s15 offen offset:2048 sc1
    buffer_load_dwordx4 v[104:107], v1, s[28:31], s15 offen offset:3072 sc1
    s_nop 6
    v_add_f32 v148, s65, v148
    v_rcp_f32 v148, v148
    v_add_f32 v164, s65, v164
    v_rcp_f32_e64 v164, v164
    v_pk_mul_f32 v[140:141], v[140:141], v[148:149] op_sel_hi:[1,0]
    v_pk_mul_f32 v[142:143], v[142:143], v[148:149] op_sel_hi:[1,0]
    v_pk_mul_f32 v[144:145], v[144:145], v[148:149] op_sel_hi:[1,0]
    v_pk_mul_f32 v[146:147], v[146:147], v[148:149] op_sel_hi:[1,0]
    v_cvt_pk_bf16_f32 v76, v140, v141
    v_cvt_pk_bf16_f32 v77, v142, v143
    v_cvt_pk_bf16_f32 v78, v144, v145
    v_cvt_pk_bf16_f32 v79, v146, v147
    ds_write_b128 v184, v[76:79] offset:0
    v_mfma_f32_32x32x16_bf16 v[140:155], v[116:119], v[84:87], 0
    v_mul_f32 v156, v156, v164
    v_mul_f32 v157, v157, v164
    v_mul_f32 v158, v158, v164
    v_mul_f32 v159, v159, v164
    v_mul_f32 v160, v160, v164
    v_mul_f32 v161, v161, v164
    v_mul_f32 v162, v162, v164
    v_mul_f32 v163, v163, v164
    v_cvt_pk_bf16_f32 v80, v156, v157
    v_cvt_pk_bf16_f32 v81, v158, v159
    v_cvt_pk_bf16_f32 v82, v160, v161
    v_cvt_pk_bf16_f32 v83, v162, v163
    ds_write_b128 v184, v[80:83] offset:1024
    v_mfma_f32_32x32x16_bf16 v[156:171], v[120:123], v[88:91], 0
    buffer_load_dwordx4 v[124:127], v1, s[28:31], s13 offen offset:0 sc1
    buffer_load_dwordx4 v[128:131], v1, s[28:31], s13 offen offset:1024 sc1
    buffer_load_dwordx4 v[132:135], v1, s[28:31], s13 offen offset:2048 sc1
    buffer_load_dwordx4 v[136:139], v1, s[28:31], s13 offen offset:3072 sc1
    s_add_u32 m0, s98, 65536
    s_add_u32 s86, s94, 262144
    buffer_load_dwordx4 v13, s[24:27], s86 offen offset:0 lds
    v_add_f32 v148, s65, v148
    v_rcp_f32 v148, v148
    s_nop 2
    v_add_f32 v164, s65, v164
    v_rcp_f32 v164, v164
    s_add_u32 s86, s94, 265216
    buffer_load_dwordx4 v13, s[24:27], s86 offen offset:1024 lds
    s_waitcnt lgkmcnt(15)
    v_mfma_f32_32x32x16_bf16 v[34:49], a[192:195], v[76:79], v[34:49]
    v_mul_f32 v140, v140, v148
    v_mul_f32 v141, v141, v148
    v_mul_f32 v142, v142, v148
    s_add_u32 s86, s94, 268288
    buffer_load_dwordx4 v13, s[24:27], s86 offen offset:2048 lds
    v_mul_f32 v143, v143, v148
    v_mul_f32 v144, v144, v148
    v_mul_f32 v145, v145, v148
    v_mul_f32 v146, v146, v148
    s_add_u32 s86, s94, 271360
    buffer_load_dwordx4 v13, s[24:27], s86 offen offset:3072 lds
    v_mul_f32 v147, v147, v148
    v_cvt_pk_bf16_f32 v84, v140, v141
    v_cvt_pk_bf16_f32 v85, v142, v143
    v_cvt_pk_bf16_f32 v86, v144, v145
    s_add_u32 m0, s99, 65536
    s_add_u32 s86, s95, 262144
    buffer_load_dwordx4 v13, s[24:27], s86 offen offset:0 lds
    v_cvt_pk_bf16_f32 v87, v146, v147
    ds_write_b128 v184, v[84:87] offset:2048
    v_mfma_f32_32x32x16_bf16 v[34:49], a[196:199], v[80:83], v[34:49]
    v_mul_f32 v156, v156, v164
    s_add_u32 s86, s95, 265216
    buffer_load_dwordx4 v13, s[24:27], s86 offen offset:1024 lds
    v_mul_f32 v157, v157, v164
    v_mul_f32 v158, v158, v164
    v_mul_f32 v159, v159, v164
    v_mul_f32 v160, v160, v164
    s_add_u32 s86, s95, 268288
    buffer_load_dwordx4 v13, s[24:27], s86 offen offset:2048 lds
    v_mul_f32 v161, v161, v164
    v_mul_f32 v162, v162, v164
    v_mul_f32 v163, v163, v164
    v_cvt_pk_bf16_f32 v88, v156, v157
    s_add_u32 s86, s95, 271360
    buffer_load_dwordx4 v13, s[24:27], s86 offen offset:3072 lds
    v_cvt_pk_bf16_f32 v89, v158, v159
    v_cvt_pk_bf16_f32 v90, v160, v161
    v_cvt_pk_bf16_f32 v91, v162, v163
    ds_write_b128 v184, v[88:91] offset:3072
    v_mfma_f32_32x32x16_bf16 v[34:49], a[200:203], v[84:87], v[34:49]
    s_waitcnt lgkmcnt(0)
    s_barrier
    ds_read_b128 v[108:111], v180 offset:0
    ds_read_b128 v[112:115], v180 offset:1024
    ds_read_b128 v[116:119], v180 offset:2048
    ds_read_b128 v[120:123], v180 offset:3072
    ds_read_b128 v[172:175], v181 offset:0
    ds_read_b128 v[176:179], v181 offset:1024
    v_mfma_f32_32x32x16_bf16 v[34:49], a[204:207], v[88:91], v[34:49]
    s_waitcnt vmcnt(14)
    v_or3_b32 v187, v93, v95, v97
    s_waitcnt vmcnt(13)
    v_or3_b32 v187, v187, v99, v101
    s_waitcnt vmcnt(12)
    v_or3_b32 v187, v187, v103, v105
    v_or_b32 v187, v187, v107
    v_ashrrev_i32 v187, 31, v187
    s_waitcnt vmcnt(11)
    v_max3_u32 v186, v187, v124, v126
    s_waitcnt vmcnt(10)
    v_max3_u32 v186, v186, v128, v130
    s_waitcnt vmcnt(9)
    v_max3_u32 v186, v186, v132, v134
    s_waitcnt vmcnt(8)
    v_max3_u32 v186, v186, v136, v138
    v_cmp_eq_u32 vcc, -1, v186
    s_nop 0
    s_cbranch_vccnz L_retry_51
L_retryjoin_52:
    v_mfma_f32_32x32x16_bf16 v[140:155], v[124:127], v[92:95], 0
    v_mfma_f32_32x32x16_bf16 v[156:171], v[128:131], v[96:99], 0
    s_waitcnt lgkmcnt(5)
    v_mfma_f32_32x32x16_bf16 v[34:49], a[208:211], v[108:111], v[34:49]
    s_nop 8
    v_add_f32 v148, s65, v148
    v_rcp_f32 v148, v148
    s_nop 0
    v_mul_f32 v140, v140, v148
    v_mul_f32 v141, v141, v148
    v_mul_f32 v142, v142, v148
    s_waitcnt lgkmcnt(4)
    v_mfma_f32_32x32x16_bf16 v[34:49], a[212:215], v[112:115], v[34:49]
    ds_read_b128 v[108:111], v181 offset:2048
    v_mul_f32 v143, v143, v148
    v_mul_f32 v144, v144, v148
    v_mul_f32 v145, v145, v148
    v_mul_f32 v146, v146, v148
    v_mul_f32_e64 v147, v147, v148
    s_waitcnt lgkmcnt(4)
    v_mfma_f32_32x32x16_bf16 v[34:49], a[216:219], v[116:119], v[34:49]
    ds_read_b128 v[112:115], v181 offset:3072
    v_cvt_pk_bf16_f32 v92, v140, v141
    v_cvt_pk_bf16_f32 v93, v142, v143
    v_cvt_pk_bf16_f32 v94, v144, v145
    v_cvt_pk_bf16_f32 v95, v146, v147
    v_mfma_f32_32x32x16_bf16 v[140:155], v[132:135], v[100:103], 0
    ds_write_b128 v184, v[92:95] offset:16384
    v_add_f32 v164, s65, v164
    v_rcp_f32 v164, v164
    s_waitcnt lgkmcnt(3)
    v_mfma_f32_32x32x16_bf16 v[34:49], a[220:223], v[120:123], v[34:49]
    ds_read_b128 v[116:119], v182 offset:0
    v_mul_f32 v156, v156, v164
    v_mul_f32 v157, v157, v164
    v_mul_f32 v158, v158, v164
    v_mul_f32 v159, v159, v164
    v_mul_f32 v160, v160, v164
    v_mfma_f32_32x32x16_bf16 v[34:49], a[224:227], v[172:175], v[34:49]
    ds_read_b128 v[120:123], v182 offset:1024
    v_mul_f32 v161, v161, v164
    v_mul_f32 v162, v162, v164
    v_mul_f32_e64 v163, v163, v164
    v_cvt_pk_bf16_f32 v96, v156, v157
    v_cvt_pk_bf16_f32 v97, v158, v159
    v_mfma_f32_32x32x16_bf16 v[34:49], a[228:231], v[176:179], v[34:49]
    ds_read_b128 v[172:175], v182 offset:2048
    v_cvt_pk_bf16_f32 v98, v160, v161
    v_cvt_pk_bf16_f32 v99, v162, v163
    s_waitcnt lgkmcnt(2)
    v_mfma_f32_32x32x16_bf16 v[34:49], a[232:235], v[108:111], v[34:49]
    ds_read_b128 v[176:179], v182 offset:3072
    ds_write_b128 v184, v[96:99] offset:17408
    v_add_f32 v148, s65, v148
    v_rcp_f32 v148, v148
    v_mfma_f32_32x32x16_bf16 v[156:171], v[136:139], v[104:107], 0
    v_mul_f32 v140, v140, v148
    v_mul_f32 v141, v141, v148
    v_mul_f32 v142, v142, v148
    v_mul_f32 v143, v143, v148
    v_mul_f32 v144, v144, v148
    v_mul_f32 v145, v145, v148
    v_mfma_f32_32x32x16_bf16 v[34:49], a[236:239], v[112:115], v[34:49]
    v_mul_f32 v146, v146, v148
    v_mul_f32_e64 v147, v147, v148
    v_cvt_pk_bf16_f32 v100, v140, v141
    v_cvt_pk_bf16_f32 v101, v142, v143
    v_cvt_pk_bf16_f32 v102, v144, v145
    v_cvt_pk_bf16_f32 v103, v146, v147
    v_mfma_f32_32x32x16_bf16 v[34:49], a[240:243], v[116:119], v[34:49]
    ds_write_b128 v184, v[100:103] offset:18432
    v_add_f32 v164, s65, v164
    v_rcp_f32 v164, v164
    s_waitcnt lgkmcnt(2)
    v_mfma_f32_32x32x16_bf16 v[34:49], a[244:247], v[120:123], v[34:49]
    v_mul_f32 v156, v156, v164
    v_mul_f32 v157, v157, v164
    v_mul_f32 v158, v158, v164
    v_mul_f32 v159, v159, v164
    v_mul_f32 v160, v160, v164
    v_mul_f32 v161, v161, v164
    v_mfma_f32_32x32x16_bf16 v[34:49], a[248:251], v[172:175], v[34:49]
    v_mul_f32 v162, v162, v164
    v_mul_f32_e64 v163, v163, v164
    v_cvt_pk_bf16_f32 v104, v156, v157
    v_cvt_pk_bf16_f32 v105, v158, v159
    v_cvt_pk_bf16_f32 v106, v160, v161
    v_cvt_pk_bf16_f32 v107, v162, v163
    v_mfma_f32_32x32x16_bf16 v[34:49], a[252:255], v[176:179], v[34:49]
    ds_write_b128 v184, v[104:107] offset:19456
    s_waitcnt vmcnt(0)
    s_waitcnt lgkmcnt(0)
    s_barrier
    s_add_u32 s52, s46, 0
    s_and_b32 s52, s52, 3
    s_lshl_b32 s52, s52, 14
    s_add_u32 s52, s52, 0x10000
    v_add_u32_e64 v190, s52, v11
    ds_read_b64_tr_b16 v[192:193], v190 offset:0
    ds_read_b64_tr_b16 v[194:195], v190 offset:2048
    ds_read_b64_tr_b16 v[196:197], v190 offset:4096
    ds_read_b64_tr_b16 v[198:199], v190 offset:6144
    ds_read_b64_tr_b16 v[200:201], v190 offset:8192
    ds_read_b64_tr_b16 v[202:203], v190 offset:10240
    ds_read_b64_tr_b16 v[204:205], v190 offset:12288
    ds_read_b64_tr_b16 v[206:207], v190 offset:14336
    s_add_u32 s52, s46, 1
    ds_read_b128 v[108:111], v180 offset:16384
    ds_read_b128 v[112:115], v180 offset:17408
    ds_read_b128 v[116:119], v180 offset:18432
    ds_read_b128 v[120:123], v180 offset:19456
    ds_read_b128 v[172:175], v181 offset:16384
    ds_read_b128 v[176:179], v181 offset:17408
    s_waitcnt lgkmcnt(12)
    v_mfma_f32_32x32x16_bf16 v[34:49], v[192:195], v[92:95], v[34:49]
    s_and_b32 s52, s52, 3
    s_lshl_b32 s52, s52, 14
    s_add_u32 s52, s52, 0x10000
    v_add_u32 v190, s52, v11
    s_waitcnt lgkmcnt(10)
    v_mfma_f32_32x32x16_bf16 v[34:49], v[196:199], v[96:99], v[34:49]
    ds_read_b64_tr_b16 v[208:209], v190 offset:0
    ds_read_b64_tr_b16 v[210:211], v190 offset:2048
    ds_read_b64_tr_b16 v[212:213], v190 offset:4096
    ds_read_b64_tr_b16 v[214:215], v190 offset:6144
    ds_read_b64_tr_b16 v[216:217], v190 offset:8192
    ds_read_b64_tr_b16 v[218:219], v190 offset:10240
    s_waitcnt lgkmcnt(14)
    v_mfma_f32_32x32x16_bf16 v[34:49], v[200:203], v[100:103], v[34:49]
    ds_read_b64_tr_b16 v[220:221], v190 offset:12288
    ds_read_b64_tr_b16 v[222:223], v190 offset:14336
    s_add_u32 s52, s46, 2
    s_and_b32 s52, s52, 3
    s_lshl_b32 s52, s52, 14
    s_add_u32 s52, s52, 0x10000
    s_waitcnt lgkmcnt(14)
    v_mfma_f32_32x32x16_bf16 v[34:49], v[204:207], v[104:107], v[34:49]
    v_add_u32_e64 v190, s52, v11
    s_waitcnt lgkmcnt(6)
    v_mfma_f32_32x32x16_bf16 v[34:49], v[208:211], v[108:111], v[34:49]
    ds_read_b64_tr_b16 v[224:225], v190 offset:0
    ds_read_b64_tr_b16 v[226:227], v190 offset:2048
    ds_read_b64_tr_b16 v[228:229], v190 offset:4096
    ds_read_b64_tr_b16 v[230:231], v190 offset:6144
    ds_read_b64_tr_b16 v[232:233], v190 offset:8192
    ds_read_b64_tr_b16 v[234:235], v190 offset:10240
    s_waitcnt lgkmcnt(10)
    v_mfma_f32_32x32x16_bf16 v[34:49], v[212:215], v[112:115], v[34:49]
    ds_read_b128 v[108:111], v181 offset:18432
    ds_read_b64_tr_b16 v[236:237], v190 offset:12288
    ds_read_b64_tr_b16 v[238:239], v190 offset:14336
    s_add_u32 s52, s46, 3
    s_and_b32 s52, s52, 3
    s_waitcnt lgkmcnt(11)
    v_mfma_f32_32x32x16_bf16 v[34:49], v[216:219], v[116:119], v[34:49]
    ds_read_b128 v[112:115], v181 offset:19456
    s_lshl_b32 s52, s52, 14
    s_add_u32 s52, s52, 0x10000
    v_add_u32_e64 v190, s52, v11
    s_waitcnt lgkmcnt(10)
    v_mfma_f32_32x32x16_bf16 v[34:49], v[220:223], v[120:123], v[34:49]
    ds_read_b128 v[116:119], v182 offset:16384
    ds_read_b64_tr_b16 v[240:241], v190 offset:0
    ds_read_b64_tr_b16 v[242:243], v190 offset:2048
    ds_read_b64_tr_b16 v[244:245], v190 offset:4096
    ds_read_b64_tr_b16 v[246:247], v190 offset:6144
    s_waitcnt lgkmcnt(13)
    v_mfma_f32_32x32x16_bf16 v[34:49], v[224:227], v[172:175], v[34:49]
    ds_read_b128 v[120:123], v182 offset:17408
    ds_read_b64_tr_b16 v[248:249], v190 offset:8192
    ds_read_b64_tr_b16 v[250:251], v190 offset:10240
    ds_read_b64_tr_b16 v[252:253], v190 offset:12288
    ds_read_b64_tr_b16 v[254:255], v190 offset:14336
    s_add_u32 s77, s77, 0x80000
    s_waitcnt lgkmcnt(15)
    v_mfma_f32_32x32x16_bf16 v[34:49], v[228:231], v[176:179], v[34:49]
    ds_read_b128 v[172:175], v182 offset:18432
    s_add_u32 s9, s9, 0x80000
    s_add_u32 s8, s8, 0x10000
    s_add_u32 s10, s10, 0x10000
    s_add_u32 s11, s11, 0x8000
    s_waitcnt lgkmcnt(11)
    v_mfma_f32_32x32x16_bf16 v[34:49], v[232:235], v[108:111], v[34:49]
    ds_read_b128 v[176:179], v182 offset:19456
    s_add_u32 s12, s12, 0x8000
    s_add_u32 s13, s13, 0x8000
    s_add_u32 s18, s18, 0x4000
    s_add_u32 s36, s36, 0x8000
    s_add_u32 s37, s37, 0x8000
    v_mfma_f32_32x32x16_bf16 v[34:49], v[236:239], v[112:115], v[34:49]
    s_add_u32 s14, s14, 0x8000
    s_add_u32 s15, s15, 0x8000
    s_waitcnt lgkmcnt(6)
    v_mfma_f32_32x32x16_bf16 v[34:49], v[240:243], v[116:119], v[34:49]
    v_mfma_f32_32x32x16_bf16 v[34:49], v[244:247], v[120:123], v[34:49]
    s_waitcnt lgkmcnt(0)
    v_mfma_f32_32x32x16_bf16 v[34:49], v[248:251], v[172:175], v[34:49]
    v_mfma_f32_32x32x16_bf16 v[34:49], v[252:255], v[176:179], v[34:49]
    s_nop 11
    v_pk_mul_f32 v[80:81], v[34:35], v[34:35]
    v_pk_add_f32 v[78:79], v[34:35], v[36:37]
    v_pk_fma_f32 v[80:81], v[36:37], v[36:37], v[80:81]
    v_pk_fma_f32 v[80:81], v[38:39], v[38:39], v[80:81]
    v_pk_add_f32 v[78:79], v[78:79], v[38:39]
    v_pk_fma_f32 v[80:81], v[40:41], v[40:41], v[80:81]
    v_pk_add_f32 v[78:79], v[78:79], v[40:41]
    v_pk_fma_f32 v[80:81], v[42:43], v[42:43], v[80:81]
    v_pk_add_f32 v[78:79], v[78:79], v[42:43]
    v_pk_fma_f32 v[80:81], v[44:45], v[44:45], v[80:81]
    v_pk_add_f32 v[78:79], v[78:79], v[44:45]
    v_pk_fma_f32 v[80:81], v[46:47], v[46:47], v[80:81]
    v_pk_add_f32 v[78:79], v[78:79], v[46:47]
    v_pk_fma_f32 v[80:81], v[48:49], v[48:49], v[80:81]
    v_pk_add_f32 v[78:79], v[78:79], v[48:49]
    v_add_f32 v78, v78, v79
    v_add_f32 v80, v80, v81
    s_nop 1
    v_permlane32_swap_b32 v78, v80
    v_add_f32 v76, v78, v80
    s_lshl_b32 s54, s46, 8
    v_lshrrev_b32 v72, 2, v1
    v_add_u32 v73, s54, v72
    ds_write_b32 v73, v76
    s_waitcnt lgkmcnt(0)
    s_barrier
    ds_read_b32 v76, v72 offset:0
    ds_read_b32 v77, v72 offset:256
    ds_read_b32 v78, v72 offset:512
    ds_read_b32 v79, v72 offset:768
    s_waitcnt lgkmcnt(2)
    v_add_f32 v76, v76, v77
    s_waitcnt lgkmcnt(0)
    v_add_f32 v78, v78, v79
    v_add_f32 v76, v76, v78
    v_min_u32 v76, -2, v76
    s_cmp_eq_u32 s48, 0
    s_cbranch_scc1 L_slowst_54
    s_mov_b32 exec_lo, s41
    s_mov_b32 exec_hi, s41
    buffer_store_dword v76, v5, s[28:31], s19 offen
    s_mov_b64 exec, -1
L_joinst_55:
    s_waitcnt vmcnt(0)
    s_mov_b32 s50, s49
L_poll_56:
    buffer_load_dwordx4 v[80:83], v6, s[28:31], s19 offen sc1
    s_waitcnt vmcnt(0)
    v_max3_u32 v96, v80, v81, v82
    v_max_u32 v96, v96, v83
    v_cmp_eq_u32 vcc, -1, v96
    s_nop 0
    s_cbranch_vccz L_polldone_57
    s_sub_u32 s50, s50, 1
    s_cbranch_scc0 L_poll_56
    s_mov_b32 s49, 0
    s_or_b32 s72, s72, 512
L_polldone_57:
    v_pk_add_f32 v[80:81], v[80:81], v[82:83]
    s_nop 1
    v_permlane32_swap_b32 v80, v81
    v_add_f32 v80, v80, v81
    v_mul_f32 v80, s68, v80
    v_mov_b32 v81, v80
    s_nop 1
    v_permlane32_swap_b32 v80, v81
    v_fma_f32 v81, -v80, v80, v81
    v_max_f32 v81, 0, v81
    v_add_f32 v81, s67, v81
    v_rsq_f32 v96, v81
    s_nop 0
    v_mul_f32 v98, -v80, v96
    v_pk_fma_f32 v[116:117], v[34:35], v[96:97], v[98:99] op_sel_hi:[1,0,0]
    v_pk_fma_f32 v[118:119], v[36:37], v[96:97], v[98:99] op_sel_hi:[1,0,0]
    v_pk_fma_f32 v[120:121], v[38:39], v[96:97], v[98:99] op_sel_hi:[1,0,0]
    v_pk_fma_f32 v[122:123], v[40:41], v[96:97], v[98:99] op_sel_hi:[1,0,0]
    v_pk_fma_f32 v[34:35], v[116:117], v[50:51], v[34:35]
    v_pk_fma_f32 v[36:37], v[118:119], v[52:53], v[36:37]
    v_pk_fma_f32 v[38:39], v[120:121], v[54:55], v[38:39]
    v_pk_fma_f32 v[40:41], v[122:123], v[56:57], v[40:41]
    v_cvt_pk_bf16_f32 v132, v34, v35
    v_cvt_pk_bf16_f32 v133, v36, v37
    v_cvt_pk_bf16_f32 v134, v38, v39
    v_cvt_pk_bf16_f32 v135, v40, v41
    s_cmp_eq_u32 s48, 0
    s_cbranch_scc1 L_slowst_58
    buffer_store_dwordx4 v[132:135], v7, s[28:31], s51 offen offset:0
L_joinst_59:
    v_pk_fma_f32 v[124:125], v[42:43], v[96:97], v[98:99] op_sel_hi:[1,0,0]
    v_pk_fma_f32 v[126:127], v[44:45], v[96:97], v[98:99] op_sel_hi:[1,0,0]
    v_pk_fma_f32 v[128:129], v[46:47], v[96:97], v[98:99] op_sel_hi:[1,0,0]
    v_pk_fma_f32 v[130:131], v[48:49], v[96:97], v[98:99] op_sel_hi:[1,0,0]
    v_pk_fma_f32 v[42:43], v[124:125], v[58:59], v[42:43]
    v_pk_fma_f32 v[44:45], v[126:127], v[60:61], v[44:45]
    v_pk_fma_f32 v[46:47], v[128:129], v[62:63], v[46:47]
    v_pk_fma_f32 v[48:49], v[130:131], v[64:65], v[48:49]
    v_cvt_pk_bf16_f32 v136, v42, v43
    v_cvt_pk_bf16_f32 v137, v44, v45
    v_cvt_pk_bf16_f32 v138, v46, v47
    v_cvt_pk_bf16_f32 v139, v48, v49
    s_cmp_eq_u32 s48, 0
    s_cbranch_scc1 L_slowst_60
    buffer_store_dwordx4 v[136:139], v7, s[28:31], s51 offen offset:256
L_joinst_61:
    v_pk_mul_f32 v[128:129], v[34:35], v[34:35]
    v_pk_add_f32 v[126:127], v[34:35], v[36:37]
    v_pk_fma_f32 v[128:129], v[36:37], v[36:37], v[128:129]
    v_pk_fma_f32 v[128:129], v[38:39], v[38:39], v[128:129]
    v_pk_add_f32 v[126:127], v[126:127], v[38:39]
    v_pk_fma_f32 v[128:129], v[40:41], v[40:41], v[128:129]
    v_pk_add_f32 v[126:127], v[126:127], v[40:41]
    v_pk_fma_f32 v[128:129], v[42:43], v[42:43], v[128:129]
    v_pk_add_f32 v[126:127], v[126:127], v[42:43]
    v_pk_fma_f32 v[128:129], v[44:45], v[44:45], v[128:129]
    v_pk_add_f32 v[126:127], v[126:127], v[44:45]
    v_pk_fma_f32 v[128:129], v[46:47], v[46:47], v[128:129]
    v_pk_add_f32 v[126:127], v[126:127], v[46:47]
    v_pk_fma_f32 v[128:129], v[48:49], v[48:49], v[128:129]
    v_pk_add_f32 v[126:127], v[126:127], v[48:49]
    v_add_f32 v126, v126, v127
    v_add_f32 v128, v128, v129
    s_nop 1
    v_permlane32_swap_b32 v126, v128
    v_add_f32 v124, v126, v128
    s_lshl_b32 s54, s46, 8
    v_lshrrev_b32 v72, 2, v1
    v_add_u32 v72, 0x400, v72
    v_add_u32 v73, s54, v72
    ds_write_b32 v73, v124
    s_waitcnt vmcnt(0)
    s_cmp_eq_u32 s48, 0
    s_cbranch_scc1 L_slowst_62
    s_mov_b64 exec, 1
    buffer_store_dwordx2 v[18:19], off, s[28:31], s3 offset:1024
    s_mov_b64 exec, -1
L_joinst_63:
    s_add_u32 m0, s73, 65536
    s_mov_b32 s53, s83
    s_waitcnt lgkmcnt(0)
    s_barrier
    buffer_load_dwordx2 v[140:141], v4, s[28:31], s60 offen offset:1024 sc1
    ds_read_b32 v108, v72 offset:0
    ds_read_b32 v109, v72 offset:256
    ds_read_b32 v110, v72 offset:512
    ds_read_b32 v111, v72 offset:768
    s_waitcnt lgkmcnt(2)
    v_add_f32 v108, v108, v109
    s_waitcnt lgkmcnt(0)
    v_add_f32 v110, v110, v111
    v_add_f32 v108, v108, v110
    v_min_u32 v108, -2, v108
    s_cmp_eq_u32 s48, 0
    s_cbranch_scc1 L_slowst_64
    s_mov_b32 exec_lo, s41
    s_mov_b32 exec_hi, s41
    buffer_store_dword v108, v5, s[28:31], s18 offen
    s_mov_b64 exec, -1
L_joinst_65:
    s_waitcnt vmcnt(1)
    v_cmp_ne_u64 vcc, s[42:43], v[140:141]
    s_nop 0
    s_cbranch_vccz L_latedone_67
    s_mov_b32 s50, s49
L_late_66:
    buffer_load_dwordx2 v[140:141], v4, s[28:31], s60 offen offset:1024 sc1
    s_waitcnt vmcnt(0)
    v_cmp_ne_u64 vcc, s[42:43], v[140:141]
    s_nop 0
    s_cbranch_vccz L_latedone_67
    s_sub_u32 s50, s50, 1
    s_cbranch_scc0 L_late_66
    s_mov_b32 s49, 0
    s_or_b32 s72, s72, 8
L_latedone_67:
    buffer_load_dwordx4 v1, s[28:31], s53 offen offset:0 sc1 lds
    buffer_load_dwordx4 v1, s[28:31], s53 offen offset:1024 sc1 lds
    buffer_load_dwordx4 v1, s[28:31], s53 offen offset:2048 sc1 lds
    buffer_load_dwordx4 v1, s[28:31], s53 offen offset:3072 sc1 lds
    s_add_u32 m0, m0, 4096
    s_add_u32 s53, s53, 0x1000
    buffer_load_dwordx4 v1, s[28:31], s53 offen offset:0 sc1 lds
    buffer_load_dwordx4 v1, s[28:31], s53 offen offset:1024 sc1 lds
    buffer_load_dwordx4 v1, s[28:31], s53 offen offset:2048 sc1 lds
    buffer_load_dwordx4 v1, s[28:31], s53 offen offset:3072 sc1 lds
    s_waitcnt vmcnt(6)
    s_barrier
    ds_read_b128 v[76:79], v0 offset:0
    ds_read_b128 v[80:83], v0 offset:16384
    ds_read_b128 v[84:87], v0 offset:32768
    ds_read_b128 v[88:91], v0 offset:49152
    s_waitcnt lgkmcnt(3)
    v_mfma_f32_16x16x32_bf16 v[108:111], v[76:79], a[0:3], 0
    ds_read_b128 v[92:95], v0 offset:1024
    s_add_u32 m0, m0, 4096
    v_mfma_f32_16x16x32_bf16 v[124:127], v[76:79], a[64:67], 0
    ds_read_b128 v[96:99], v0 offset:17408
    s_add_u32 s53, s53, 0x1000
    s_waitcnt lgkmcnt(4)
    v_mfma_f32_16x16x32_bf16 v[112:115], v[80:83], a[0:3], 0
    ds_read_b128 v[100:103], v0 offset:33792
    v_mfma_f32_16x16x32_bf16 v[128:131], v[80:83], a[64:67], 0
    ds_read_b128 v[104:107], v0 offset:50176
    s_waitcnt lgkmcnt(5)
    v_mfma_f32_16x16x32_bf16 v[116:119], v[84:87], a[0:3], 0
    buffer_load_dwordx4 v1, s[28:31], s53 offen offset:0 sc1 lds
    v_mfma_f32_16x16x32_bf16 v[132:135], v[84:87], a[64:67], 0
    s_waitcnt lgkmcnt(4)
    v_mfma_f32_16x16x32_bf16 v[120:123], v[88:91], a[0:3], 0
    buffer_load_dwordx2 v[172:173], v189, s[28:31], s18 offen sc1
    v_mfma_f32_16x16x32_bf16 v[136:139], v[88:91], a[64:67], 0
    s_waitcnt vmcnt(6)
    s_barrier
    s_waitcnt lgkmcnt(0)
    v_mfma_f32_16x16x32_bf16 v[108:111], v[92:95], a[4:7], v[108:111]
    ds_read_b128 v[76:79], v0 offset:2048
    v_mfma_f32_16x16x32_bf16 v[124:127], v[92:95], a[68:71], v[124:127]
    ds_read_b128 v[80:83], v0 offset:18432
    v_mfma_f32_16x16x32_bf16 v[112:115], v[96:99], a[4:7], v[112:115]
    ds_read_b128 v[84:87], v0 offset:34816
    v_mfma_f32_16x16x32_bf16 v[128:131], v[96:99], a[68:71], v[128:131]
    ds_read_b128 v[88:91], v0 offset:51200
    v_mfma_f32_16x16x32_bf16 v[116:119], v[100:103], a[4:7], v[116:119]
    buffer_load_dwordx4 v1, s[28:31], s53 offen offset:1024 sc1 lds
    v_mfma_f32_16x16x32_bf16 v[132:135], v[100:103], a[68:71], v[132:135]
    v_mfma_f32_16x16x32_bf16 v[120:123], v[104:107], a[4:7], v[120:123]
    buffer_load_dwordx4 v1, s[28:31], s53 offen offset:2048 sc1 lds
    v_mfma_f32_16x16x32_bf16 v[136:139], v[104:107], a[68:71], v[136:139]
    s_waitcnt lgkmcnt(0)
    v_mfma_f32_16x16x32_bf16 v[108:111], v[76:79], a[8:11], v[108:111]
    ds_read_b128 v[92:95], v0 offset:3072
    v_mfma_f32_16x16x32_bf16 v[124:127], v[76:79], a[72:75], v[124:127]
    ds_read_b128 v[96:99], v0 offset:19456
    v_mfma_f32_16x16x32_bf16 v[112:115], v[80:83], a[8:11], v[112:115]
    ds_read_b128 v[100:103], v0 offset:35840
    v_mfma_f32_16x16x32_bf16 v[128:131], v[80:83], a[72:75], v[128:131]
    ds_read_b128 v[104:107], v0 offset:52224
    v_mfma_f32_16x16x32_bf16 v[116:119], v[84:87], a[8:11], v[116:119]
    buffer_load_dwordx4 v1, s[28:31], s53 offen offset:3072 sc1 lds
    v_mfma_f32_16x16x32_bf16 v[132:135], v[84:87], a[72:75], v[132:135]
    s_add_u32 m0, m0, 4096
    s_add_u32 s53, s53, 0x1000
    v_mfma_f32_16x16x32_bf16 v[120:123], v[88:91], a[8:11], v[120:123]
    buffer_load_dwordx4 v1, s[28:31], s53 offen offset:0 sc1 lds
    v_mfma_f32_16x16x32_bf16 v[136:139], v[88:91], a[72:75], v[136:139]
    s_waitcnt vmcnt(7)
    s_barrier
    s_waitcnt lgkmcnt(0)
    v_mfma_f32_16x16x32_bf16 v[108:111], v[92:95], a[12:15], v[108:111]
    ds_read_b128 v[76:79], v0 offset:4096
    v_mfma_f32_16x16x32_bf16 v[124:127], v[92:95], a[76:79], v[124:127]
    ds_read_b128 v[80:83], v0 offset:20480
    v_mfma_f32_16x16x32_bf16 v[112:115], v[96:99], a[12:15], v[112:115]
    ds_read_b128 v[84:87], v0 offset:36864
    v_mfma_f32_16x16x32_bf16 v[128:131], v[96:99], a[76:79], v[128:131]
    ds_read_b128 v[88:91], v0 offset:53248
    v_mfma_f32_16x16x32_bf16 v[116:119], v[100:103], a[12:15], v[116:119]
    buffer_load_dwordx4 v1, s[28:31], s53 offen offset:1024 sc1 lds
    v_mfma_f32_16x16x32_bf16 v[132:135], v[100:103], a[76:79], v[132:135]
    v_mfma_f32_16x16x32_bf16 v[120:123], v[104:107], a[12:15], v[120:123]
    buffer_load_dwordx4 v1, s[28:31], s53 offen offset:2048 sc1 lds
    v_mfma_f32_16x16x32_bf16 v[136:139], v[104:107], a[76:79], v[136:139]
    s_waitcnt lgkmcnt(0)
    v_mfma_f32_16x16x32_bf16 v[108:111], v[76:79], a[16:19], v[108:111]
    ds_read_b128 v[92:95], v0 offset:5120
    v_mfma_f32_16x16x32_bf16 v[124:127], v[76:79], a[80:83], v[124:127]
    ds_read_b128 v[96:99], v0 offset:21504
    v_mfma_f32_16x16x32_bf16 v[112:115], v[80:83], a[16:19], v[112:115]
    ds_read_b128 v[100:103], v0 offset:37888
    v_mfma_f32_16x16x32_bf16 v[128:131], v[80:83], a[80:83], v[128:131]
    ds_read_b128 v[104:107], v0 offset:54272
    v_mfma_f32_16x16x32_bf16 v[116:119], v[84:87], a[16:19], v[116:119]
    buffer_load_dwordx4 v1, s[28:31], s53 offen offset:3072 sc1 lds
    v_mfma_f32_16x16x32_bf16 v[132:135], v[84:87], a[80:83], v[132:135]
    v_mfma_f32_16x16x32_bf16 v[120:123], v[88:91], a[16:19], v[120:123]
    v_mfma_f32_16x16x32_bf16 v[136:139], v[88:91], a[80:83], v[136:139]
    s_waitcnt lgkmcnt(0)
    v_mfma_f32_16x16x32_bf16 v[108:111], v[92:95], a[20:23], v[108:111]
    ds_read_b128 v[76:79], v0 offset:6144
    s_waitcnt vmcnt(7)
    v_max_u32_e64 v180, v172, v173
    v_mfma_f32_16x16x32_bf16 v[124:127], v[92:95], a[84:87], v[124:127]
    ds_read_b128 v[80:83], v0 offset:22528
    v_mfma_f32_16x16x32_bf16 v[112:115], v[96:99], a[20:23], v[112:115]
    ds_read_b128 v[84:87], v0 offset:38912
    v_mfma_f32_16x16x32_bf16 v[128:131], v[96:99], a[84:87], v[128:131]
    ds_read_b128 v[88:91], v0 offset:55296
    v_mfma_f32_16x16x32_bf16 v[116:119], v[100:103], a[20:23], v[116:119]
    v_cmp_eq_u32 vcc, -1, v180
    s_nop 0
    s_cbranch_vccnz L_retry_69
L_retryjoin_70:
    v_mfma_f32_16x16x32_bf16 v[132:135], v[100:103], a[84:87], v[132:135]
    v_permlane16_swap_b32 v172, v173
    v_mfma_f32_16x16x32_bf16 v[120:123], v[104:107], a[20:23], v[120:123]
    v_add_f32 v172, v172, v173
    v_mov_b32 v173, v172
    v_mfma_f32_16x16x32_bf16 v[136:139], v[104:107], a[84:87], v[136:139]
    s_waitcnt vmcnt(5)
    s_barrier
    s_waitcnt lgkmcnt(0)
    v_mfma_f32_16x16x32_bf16 v[108:111], v[76:79], a[24:27], v[108:111]
    ds_read_b128 v[92:95], v0 offset:7168
    v_mfma_f32_16x16x32_bf16 v[124:127], v[76:79], a[88:91], v[124:127]
    ds_read_b128 v[96:99], v0 offset:23552
    v_mfma_f32_16x16x32_bf16 v[112:115], v[80:83], a[24:27], v[112:115]
    ds_read_b128 v[100:103], v0 offset:39936
    v_mfma_f32_16x16x32_bf16 v[128:131], v[80:83], a[88:91], v[128:131]
    ds_read_b128 v[104:107], v0 offset:56320
    v_mfma_f32_16x16x32_bf16 v[116:119], v[84:87], a[24:27], v[116:119]
    v_permlane32_swap_b32 v172, v173
    v_mfma_f32_16x16x32_bf16 v[132:135], v[84:87], a[88:91], v[132:135]
    v_add_f32 v172, v172, v173
    v_mul_f32 v172, s68, v172
    v_mfma_f32_16x16x32_bf16 v[120:123], v[88:91], a[24:27], v[120:123]
    v_mov_b32 v173, v172
    v_mfma_f32_16x16x32_bf16 v[136:139], v[88:91], a[88:91], v[136:139]
    s_waitcnt lgkmcnt(0)
    v_mfma_f32_16x16x32_bf16 v[108:111], v[92:95], a[28:31], v[108:111]
    ds_read_b128 v[76:79], v0 offset:8192
    v_mfma_f32_16x16x32_bf16 v[124:127], v[92:95], a[92:95], v[124:127]
    ds_read_b128 v[80:83], v0 offset:24576
    v_mfma_f32_16x16x32_bf16 v[112:115], v[96:99], a[28:31], v[112:115]
    ds_read_b128 v[84:87], v0 offset:40960
    v_mfma_f32_16x16x32_bf16 v[128:131], v[96:99], a[92:95], v[128:131]
    ds_read_b128 v[88:91], v0 offset:57344
    v_mfma_f32_16x16x32_bf16 v[116:119], v[100:103], a[28:31], v[116:119]
    v_permlane16_swap_b32 v172, v173
    v_mfma_f32_16x16x32_bf16 v[132:135], v[100:103], a[92:95], v[132:135]
    v_fma_f32 v173, -v172, v172, v173
    v_max_f32 v173, 0, v173
    v_mfma_f32_16x16x32_bf16 v[120:123], v[104:107], a[28:31], v[120:123]
    v_add_f32 v173, s67, v173
    v_mfma_f32_16x16x32_bf16 v[136:139], v[104:107], a[92:95], v[136:139]
    s_waitcnt lgkmcnt(0)
    v_mfma_f32_16x16x32_bf16 v[108:111], v[76:79], a[32:35], v[108:111]
    ds_read_b128 v[92:95], v0 offset:9216
    v_mfma_f32_16x16x32_bf16 v[124:127], v[76:79], a[96:99], v[124:127]
    ds_read_b128 v[96:99], v0 offset:25600
    v_mfma_f32_16x16x32_bf16 v[112:115], v[80:83], a[32:35], v[112:115]
    ds_read_b128 v[100:103], v0 offset:41984
    v_mfma_f32_16x16x32_bf16 v[128:131], v[80:83], a[96:99], v[128:131]
    ds_read_b128 v[104:107], v0 offset:58368
    v_mfma_f32_16x16x32_bf16 v[116:119], v[84:87], a[32:35], v[116:119]
    v_rsq_f32_e64 v174, v173
    v_mfma_f32_16x16x32_bf16 v[132:135], v[84:87], a[96:99], v[132:135]
    v_mul_f32 v175, -v172, v174
    v_cndmask_b32 v174, v174, v175, s[38:39]
    v_mfma_f32_16x16x32_bf16 v[120:123], v[88:91], a[32:35], v[120:123]
    ds_write_b32 v17, v174
    v_mfma_f32_16x16x32_bf16 v[136:139], v[88:91], a[96:99], v[136:139]
    s_waitcnt lgkmcnt(1)
    v_mfma_f32_16x16x32_bf16 v[108:111], v[92:95], a[36:39], v[108:111]
    ds_read_b128 v[76:79], v0 offset:10240
    v_mfma_f32_16x16x32_bf16 v[124:127], v[92:95], a[100:103], v[124:127]
    ds_read_b128 v[80:83], v0 offset:26624
    v_mfma_f32_16x16x32_bf16 v[112:115], v[96:99], a[36:39], v[112:115]
    ds_read_b128 v[84:87], v0 offset:43008
    v_mfma_f32_16x16x32_bf16 v[128:131], v[96:99], a[100:103], v[128:131]
    ds_read_b128 v[88:91], v0 offset:59392
    v_mfma_f32_16x16x32_bf16 v[116:119], v[100:103], a[36:39], v[116:119]
    s_cmp_lg_u32 s74, 0
    s_cbranch_scc1 L_wb_72
    buffer_wbl2 sc1
L_wb_72:
    v_mfma_f32_16x16x32_bf16 v[132:135], v[100:103], a[100:103], v[132:135]
    v_mfma_f32_16x16x32_bf16 v[120:123], v[104:107], a[36:39], v[120:123]
    v_mfma_f32_16x16x32_bf16 v[136:139], v[104:107], a[100:103], v[136:139]
    s_waitcnt vmcnt(0)
    s_waitcnt lgkmcnt(4)
    s_barrier
    s_waitcnt lgkmcnt(0)
    v_mfma_f32_16x16x32_bf16 v[108:111], v[76:79], a[40:43], v[108:111]
    ds_read_b128 v[92:95], v0 offset:11264
    ds_read_b128 v[156:159], v14 offset:256
    v_mfma_f32_16x16x32_bf16 v[124:127], v[76:79], a[104:107], v[124:127]
    ds_read_b128 v[96:99], v0 offset:27648
    ds_read_b128 v[160:163], v14 offset:320
    v_mfma_f32_16x16x32_bf16 v[112:115], v[80:83], a[40:43], v[112:115]
    ds_read_b128 v[100:103], v0 offset:44032
    ds_read_b128 v[164:167], v14 offset:384
    v_mfma_f32_16x16x32_bf16 v[128:131], v[80:83], a[104:107], v[128:131]
    ds_read_b128 v[104:107], v0 offset:60416
    ds_read_b128 v[168:171], v14 offset:448
    v_mfma_f32_16x16x32_bf16 v[116:119], v[84:87], a[40:43], v[116:119]
    ds_read_b128 v[140:143], v14 offset:0
    ds_read_b128 v[144:147], v14 offset:64
    v_mfma_f32_16x16x32_bf16 v[132:135], v[84:87], a[104:107], v[132:135]
    ds_read_b128 v[148:151], v14 offset:128
    ds_read_b128 v[152:155], v14 offset:192
    v_mfma_f32_16x16x32_bf16 v[120:123], v[88:91], a[40:43], v[120:123]
    v_mfma_f32_16x16x32_bf16 v[136:139], v[88:91], a[104:107], v[136:139]
    s_waitcnt lgkmcnt(5)
    v_mfma_f32_16x16x32_bf16 v[108:111], v[92:95], a[44:47], v[108:111]
    ds_read_b128 v[76:79], v0 offset:12288
    v_mfma_f32_16x16x32_bf16 v[124:127], v[92:95], a[108:111], v[124:127]
    ds_read_b128 v[80:83], v0 offset:28672
    v_mfma_f32_16x16x32_bf16 v[112:115], v[96:99], a[44:47], v[112:115]
    ds_read_b128 v[84:87], v0 offset:45056
    v_mfma_f32_16x16x32_bf16 v[128:131], v[96:99], a[108:111], v[128:131]
    ds_read_b128 v[88:91], v0 offset:61440
    v_mfma_f32_16x16x32_bf16 v[116:119], v[100:103], a[44:47], v[116:119]
    v_fma_f32 v172, v156, v28, s65
    v_mul_f32 v156, v156, v29
    v_mfma_f32_16x16x32_bf16 v[132:135], v[100:103], a[108:111], v[132:135]
    v_fma_f32 v173, v157, v28, s65
    v_mul_f32 v157, v157, v29
    v_mfma_f32_16x16x32_bf16 v[120:123], v[104:107], a[44:47], v[120:123]
    v_fma_f32 v174, v158, v28, s65
    v_mul_f32 v158, v158, v29
    v_mfma_f32_16x16x32_bf16 v[136:139], v[104:107], a[108:111], v[136:139]
    v_fma_f32 v175, v159, v28, s65
    s_waitcnt lgkmcnt(0)
    v_mfma_f32_16x16x32_bf16 v[108:111], v[76:79], a[48:51], v[108:111]
    ds_read_b128 v[92:95], v0 offset:13312
    v_mul_f32_e64 v159, v159, v29
    v_mfma_f32_16x16x32_bf16 v[124:127], v[76:79], a[112:115], v[124:127]
    ds_read_b128 v[96:99], v0 offset:29696
    v_fma_f32 v176, v160, v28, s65
    v_mfma_f32_16x16x32_bf16 v[112:115], v[80:83], a[48:51], v[112:115]
    ds_read_b128 v[100:103], v0 offset:46080
    v_mul_f32_e64 v160, v160, v29
    v_mfma_f32_16x16x32_bf16 v[128:131], v[80:83], a[112:115], v[128:131]
    ds_read_b128 v[104:107], v0 offset:62464
    v_fma_f32 v177, v161, v28, s65
    v_mfma_f32_16x16x32_bf16 v[116:119], v[84:87], a[48:51], v[116:119]
    v_mul_f32 v161, v161, v29
    v_fma_f32 v178, v162, v28, s65
    v_mfma_f32_16x16x32_bf16 v[132:135], v[84:87], a[112:115], v[132:135]
    v_mul_f32 v162, v162, v29
    v_fma_f32 v179, v163, v28, s65
    v_mfma_f32_16x16x32_bf16 v[120:123], v[88:91], a[48:51], v[120:123]
    v_mul_f32 v163, v163, v29
    v_fma_f32 v180, v164, v28, s65
    v_mfma_f32_16x16x32_bf16 v[136:139], v[88:91], a[112:115], v[136:139]
    v_mul_f32_e64 v164, v164, v29
    s_waitcnt lgkmcnt(0)
    v_mfma_f32_16x16x32_bf16 v[108:111], v[92:95], a[52:55], v[108:111]
    ds_read_b128 v[76:79], v0 offset:14336
    v_fma_f32 v181, v165, v28, s65
    v_mfma_f32_16x16x32_bf16 v[124:127], v[92:95], a[116:119], v[124:127]
    ds_read_b128 v[80:83], v0 offset:30720
    v_mul_f32_e64 v165, v165, v29
    v_mfma_f32_16x16x32_bf16 v[112:115], v[96:99], a[52:55], v[112:115]
    ds_read_b128 v[84:87], v0 offset:47104
    v_fma_f32 v182, v166, v28, s65
    v_mfma_f32_16x16x32_bf16 v[128:131], v[96:99], a[116:119], v[128:131]
    ds_read_b128 v[88:91], v0 offset:63488
    v_mul_f32 v166, v166, v29
    v_mfma_f32_16x16x32_bf16 v[116:119], v[100:103], a[52:55], v[116:119]
    v_fma_f32 v183, v167, v28, s65
    v_mul_f32 v167, v167, v29
    v_mfma_f32_16x16x32_bf16 v[132:135], v[100:103], a[116:119], v[132:135]
    v_fma_f32 v184, v168, v28, s65
    v_mul_f32 v168, v168, v29
    v_mfma_f32_16x16x32_bf16 v[120:123], v[104:107], a[52:55], v[120:123]
    v_fma_f32 v185, v169, v28, s65
    v_mul_f32 v169, v169, v29
    v_mfma_f32_16x16x32_bf16 v[136:139], v[104:107], a[116:119], v[136:139]
    v_fma_f32 v186, v170, v28, s65
    s_waitcnt lgkmcnt(0)
    v_mfma_f32_16x16x32_bf16 v[108:111], v[76:79], a[56:59], v[108:111]
    ds_read_b128 v[92:95], v0 offset:15360
    v_mul_f32 v170, v170, v29
    v_mfma_f32_16x16x32_bf16 v[124:127], v[76:79], a[120:123], v[124:127]
    ds_read_b128 v[96:99], v0 offset:31744
    v_fma_f32 v187, v171, v28, s65
    v_mfma_f32_16x16x32_bf16 v[112:115], v[80:83], a[56:59], v[112:115]
    ds_read_b128 v[100:103], v0 offset:48128
    v_mul_f32_e64 v171, v171, v29
    v_mfma_f32_16x16x32_bf16 v[128:131], v[80:83], a[120:123], v[128:131]
    ds_read_b128 v[104:107], v0 offset:64512
    v_mfma_f32_16x16x32_bf16 v[116:119], v[84:87], a[56:59], v[116:119]
    v_mfma_f32_16x16x32_bf16 v[132:135], v[84:87], a[120:123], v[132:135]
    v_mfma_f32_16x16x32_bf16 v[120:123], v[88:91], a[56:59], v[120:123]
    v_mfma_f32_16x16x32_bf16 v[136:139], v[88:91], a[120:123], v[136:139]
    s_waitcnt lgkmcnt(0)
    v_mfma_f32_16x16x32_bf16 v[108:111], v[92:95], a[60:63], v[108:111]
    v_mfma_f32_16x16x32_bf16 v[124:127], v[92:95], a[124:127], v[124:127]
    v_mfma_f32_16x16x32_bf16 v[112:115], v[96:99], a[60:63], v[112:115]
    v_mfma_f32_16x16x32_bf16 v[128:131], v[96:99], a[124:127], v[128:131]
    v_mfma_f32_16x16x32_bf16 v[116:119], v[100:103], a[60:63], v[116:119]
    v_mfma_f32_16x16x32_bf16 v[132:135], v[100:103], a[124:127], v[132:135]
    v_mfma_f32_16x16x32_bf16 v[120:123], v[104:107], a[60:63], v[120:123]
    v_mfma_f32_16x16x32_bf16 v[136:139], v[104:107], a[124:127], v[136:139]
    s_nop 0
    v_pk_fma_f32 v[108:109], v[108:109], v[140:141], v[172:173]
    v_pk_fma_f32 v[110:111], v[110:111], v[142:143], v[174:175]
    v_pk_mul_f32 v[92:93], v[108:109], s[84:85]
    v_pk_mul_f32 v[94:95], v[110:111], s[84:85]
    v_pk_fma_f32 v[124:125], v[124:125], v[140:141], v[156:157]
    v_pk_fma_f32 v[126:127], v[126:127], v[142:143], v[158:159]
    v_exp_f32_e64 v92, v92 clamp
    v_exp_f32_e64 v93, v93 clamp
    v_exp_f32_e64 v94, v94 clamp
    v_exp_f32_e64 v95, v95 clamp
    v_max_f32 v108, s65, v108
    v_max_f32 v109, s65, v109
    v_max_f32 v110, s65, v110
    v_max_f32 v111, s65, v111
    v_pk_add_f32 v[108:109], v[108:109], v[92:93]
    v_pk_add_f32 v[110:111], v[110:111], v[94:95]
    v_cvt_pk_bf16_f32 v84, v124, v125
    v_cvt_pk_bf16_f32 v85, v126, v127
    v_cvt_pk_bf16_f32 v76, v108, v109
    v_cvt_pk_bf16_f32 v77, v110, v111
    v_pk_fma_f32 v[112:113], v[112:113], v[144:145], v[176:177]
    v_pk_fma_f32 v[114:115], v[114:115], v[146:147], v[178:179]
    v_pk_mul_f32 v[92:93], v[112:113], s[84:85]
    v_pk_mul_f32 v[94:95], v[114:115], s[84:85]
    v_pk_fma_f32 v[128:129], v[128:129], v[144:145], v[160:161]
    v_pk_fma_f32 v[130:131], v[130:131], v[146:147], v[162:163]
    v_exp_f32_e64 v92, v92 clamp
    v_exp_f32_e64 v93, v93 clamp
    v_exp_f32_e64 v94, v94 clamp
    v_exp_f32_e64 v95, v95 clamp
    v_max_f32 v112, s65, v112
    v_max_f32 v113, s65, v113
    v_max_f32 v114, s65, v114
    v_max_f32 v115, s65, v115
    v_pk_add_f32 v[112:113], v[112:113], v[92:93]
    v_pk_add_f32 v[114:115], v[114:115], v[94:95]
    v_cvt_pk_bf16_f32 v86, v128, v129
    v_cvt_pk_bf16_f32 v87, v130, v131
    v_cvt_pk_bf16_f32 v78, v112, v113
    v_cvt_pk_bf16_f32 v79, v114, v115
    v_pk_fma_f32 v[116:117], v[116:117], v[148:149], v[180:181]
    v_pk_fma_f32 v[118:119], v[118:119], v[150:151], v[182:183]
    v_pk_mul_f32 v[92:93], v[116:117], s[84:85]
    v_pk_mul_f32 v[94:95], v[118:119], s[84:85]
    v_pk_fma_f32 v[132:133], v[132:133], v[148:149], v[164:165]
    v_pk_fma_f32 v[134:135], v[134:135], v[150:151], v[166:167]
    v_exp_f32_e64 v92, v92 clamp
    v_exp_f32_e64 v93, v93 clamp
    v_exp_f32_e64 v94, v94 clamp
    v_exp_f32_e64 v95, v95 clamp
    v_max_f32 v116, s65, v116
    v_max_f32 v117, s65, v117
    v_max_f32 v118, s65, v118
    v_max_f32 v119, s65, v119
    v_pk_add_f32 v[116:117], v[116:117], v[92:93]
    v_pk_add_f32 v[118:119], v[118:119], v[94:95]
    v_cvt_pk_bf16_f32 v88, v132, v133
    v_cvt_pk_bf16_f32 v89, v134, v135
    v_cvt_pk_bf16_f32 v80, v116, v117
    v_cvt_pk_bf16_f32 v81, v118, v119
    v_pk_fma_f32 v[120:121], v[120:121], v[152:153], v[184:185]
    v_pk_fma_f32 v[122:123], v[122:123], v[154:155], v[186:187]
    v_pk_mul_f32 v[92:93], v[120:121], s[84:85]
    v_pk_mul_f32 v[94:95], v[122:123], s[84:85]
    v_pk_fma_f32 v[136:137], v[136:137], v[152:153], v[168:169]
    v_pk_fma_f32 v[138:139], v[138:139], v[154:155], v[170:171]
    v_exp_f32_e64 v92, v92 clamp
    v_exp_f32_e64 v93, v93 clamp
    v_exp_f32_e64 v94, v94 clamp
    v_exp_f32_e64 v95, v95 clamp
    v_max_f32 v120, s65, v120
    v_max_f32 v121, s65, v121
    v_max_f32 v122, s65, v122
    v_max_f32 v123, s65, v123
    v_pk_add_f32 v[120:121], v[120:121], v[92:93]
    v_pk_add_f32 v[122:123], v[122:123], v[94:95]
    v_cvt_pk_bf16_f32 v90, v136, v137
    v_cvt_pk_bf16_f32 v91, v138, v139
    v_cvt_pk_bf16_f32 v82, v120, v121
    v_cvt_pk_bf16_f32 v83, v122, v123
    v_mfma_f32_16x16x32_bf16 v[140:143], v[76:79], v[84:87], 0
    s_nop 0
    v_mfma_f32_16x16x32_bf16 v[140:143], v[80:83], v[88:91], v[140:143]
    v_mfma_f32_16x16x32_bf16 v[144:147], v[76:79], v[24:27], 0
    v_mfma_f32_16x16x32_bf16 v[144:147], v[80:83], v[24:27], v[144:147]
    ds_read_b32 v164, v15 offset:0
    ds_read_b32 v165, v15 offset:256
    ds_read_b32 v166, v15 offset:64
    ds_read_b32 v167, v15 offset:320
    ds_read_b32 v168, v15 offset:128
    ds_read_b32 v169, v15 offset:384
    ds_read_b32 v170, v15 offset:192
    ds_read_b32 v171, v15 offset:448
    v_cvt_pk_bf16_f32 v140, v140, v141
    v_cvt_pk_bf16_f32 v141, v142, v143
    v_min_u32 v140, -2, v140
    v_min_u32 v141, -2, v141
    buffer_store_dwordx2 v[140:141], v9, s[28:31], s77 offen sc1
    v_min_u32 v144, -2, v144
    v_min_u32 v145, -2, v145
    v_min_u32 v146, -2, v146
    v_min_u32_e64 v147, -2, v147
    s_mov_b32 exec_lo, 0x00010001
    s_mov_b32 exec_hi, 0x00010001
    buffer_store_dwordx4 v[144:147], v16, s[28:31], s8 offen sc1
    s_mov_b64 exec, -1
    ds_read_b128 v[76:79], v0 offset:0
    ds_read_b128 v[80:83], v0 offset:16384
    ds_read_b128 v[84:87], v0 offset:32768
    ds_read_b128 v[88:91], v0 offset:49152
    ds_read_b128 v[92:95], v0 offset:1024
    ds_read_b128 v[96:99], v0 offset:17408
    ds_read_b128 v[100:103], v0 offset:33792
    ds_read_b128 v[104:107], v0 offset:50176
    s_waitcnt lgkmcnt(6)
    v_mfma_f32_16x16x32_bf16 v[124:127], a[128:131], v[76:79], 0
    ds_read_b128 v[108:111], v0 offset:2048
    v_mfma_f32_16x16x32_bf16 v[128:131], a[128:131], v[80:83], 0
    ds_read_b128 v[112:115], v0 offset:18432
    s_waitcnt lgkmcnt(6)
    v_mfma_f32_16x16x32_bf16 v[132:135], a[128:131], v[84:87], 0
    ds_read_b128 v[116:119], v0 offset:34816
    v_fma_f32 v172, v165, v30, s65
    v_mfma_f32_16x16x32_bf16 v[136:139], a[128:131], v[88:91], 0
    ds_read_b128 v[120:123], v0 offset:51200
    s_waitcnt lgkmcnt(6)
    v_mfma_f32_16x16x32_bf16 v[124:127], a[132:135], v[92:95], v[124:127]
    ds_read_b128 v[76:79], v0 offset:3072
    v_fma_f32 v173, v165, v31, s65
    v_mfma_f32_16x16x32_bf16 v[128:131], a[132:135], v[96:99], v[128:131]
    ds_read_b128 v[80:83], v0 offset:19456
    s_waitcnt lgkmcnt(6)
    v_mfma_f32_16x16x32_bf16 v[132:135], a[132:135], v[100:103], v[132:135]
    ds_read_b128 v[84:87], v0 offset:35840
    v_fma_f32 v174, v165, v32, s65
    v_mfma_f32_16x16x32_bf16 v[136:139], a[132:135], v[104:107], v[136:139]
    ds_read_b128 v[88:91], v0 offset:52224
    s_waitcnt lgkmcnt(6)
    v_mfma_f32_16x16x32_bf16 v[124:127], a[136:139], v[108:111], v[124:127]
    ds_read_b128 v[92:95], v0 offset:4096
    v_fma_f32 v175, v165, v33, s65
    v_mfma_f32_16x16x32_bf16 v[128:131], a[136:139], v[112:115], v[128:131]
    ds_read_b128 v[96:99], v0 offset:20480
    s_waitcnt lgkmcnt(6)
    v_mfma_f32_16x16x32_bf16 v[132:135], a[136:139], v[116:119], v[132:135]
    ds_read_b128 v[100:103], v0 offset:36864
    v_fma_f32 v176, v167, v30, s65
    v_mfma_f32_16x16x32_bf16 v[136:139], a[136:139], v[120:123], v[136:139]
    ds_read_b128 v[104:107], v0 offset:53248
    s_waitcnt lgkmcnt(6)
    v_mfma_f32_16x16x32_bf16 v[124:127], a[140:143], v[76:79], v[124:127]
    ds_read_b128 v[108:111], v0 offset:5120
    v_fma_f32 v177, v167, v31, s65
    v_mfma_f32_16x16x32_bf16 v[128:131], a[140:143], v[80:83], v[128:131]
    ds_read_b128 v[112:115], v0 offset:21504
    s_waitcnt lgkmcnt(6)
    v_mfma_f32_16x16x32_bf16 v[132:135], a[140:143], v[84:87], v[132:135]
    ds_read_b128 v[116:119], v0 offset:37888
    v_fma_f32 v178, v167, v32, s65
    v_mfma_f32_16x16x32_bf16 v[136:139], a[140:143], v[88:91], v[136:139]
    ds_read_b128 v[120:123], v0 offset:54272
    s_waitcnt lgkmcnt(6)
    v_mfma_f32_16x16x32_bf16 v[124:127], a[144:147], v[92:95], v[124:127]
    ds_read_b128 v[76:79], v0 offset:6144
    v_fma_f32 v179, v167, v33, s65
    v_mfma_f32_16x16x32_bf16 v[128:131], a[144:147], v[96:99], v[128:131]
    ds_read_b128 v[80:83], v0 offset:22528
    s_waitcnt lgkmcnt(6)
    v_mfma_f32_16x16x32_bf16 v[132:135], a[144:147], v[100:103], v[132:135]
    ds_read_b128 v[84:87], v0 offset:38912
    v_fma_f32 v180, v169, v30, s65
    v_mfma_f32_16x16x32_bf16 v[136:139], a[144:147], v[104:107], v[136:139]
    ds_read_b128 v[88:91], v0 offset:55296
    s_waitcnt lgkmcnt(6)
    v_mfma_f32_16x16x32_bf16 v[124:127], a[148:151], v[108:111], v[124:127]
    ds_read_b128 v[92:95], v0 offset:7168
    v_fma_f32 v181, v169, v31, s65
    v_mfma_f32_16x16x32_bf16 v[128:131], a[148:151], v[112:115], v[128:131]
    ds_read_b128 v[96:99], v0 offset:23552
    s_waitcnt lgkmcnt(6)
    v_mfma_f32_16x16x32_bf16 v[132:135], a[148:151], v[116:119], v[132:135]
    ds_read_b128 v[100:103], v0 offset:39936
    v_fma_f32 v182, v169, v32, s65
    v_mfma_f32_16x16x32_bf16 v[136:139], a[148:151], v[120:123], v[136:139]
    ds_read_b128 v[104:107], v0 offset:56320
    s_waitcnt lgkmcnt(6)
    v_mfma_f32_16x16x32_bf16 v[124:127], a[152:155], v[76:79], v[124:127]
    ds_read_b128 v[108:111], v0 offset:8192
    v_fma_f32 v183, v169, v33, s65
    v_mfma_f32_16x16x32_bf16 v[128:131], a[152:155], v[80:83], v[128:131]
    ds_read_b128 v[112:115], v0 offset:24576
    s_waitcnt lgkmcnt(6)
    v_mfma_f32_16x16x32_bf16 v[132:135], a[152:155], v[84:87], v[132:135]
    ds_read_b128 v[116:119], v0 offset:40960
    v_fma_f32 v184, v171, v30, s65
    v_mfma_f32_16x16x32_bf16 v[136:139], a[152:155], v[88:91], v[136:139]
    ds_read_b128 v[120:123], v0 offset:57344
    s_waitcnt lgkmcnt(6)
    v_mfma_f32_16x16x32_bf16 v[124:127], a[156:159], v[92:95], v[124:127]
    ds_read_b128 v[76:79], v0 offset:9216
    v_fma_f32 v185, v171, v31, s65
    v_mfma_f32_16x16x32_bf16 v[128:131], a[156:159], v[96:99], v[128:131]
    ds_read_b128 v[80:83], v0 offset:25600
    s_waitcnt lgkmcnt(6)
    v_mfma_f32_16x16x32_bf16 v[132:135], a[156:159], v[100:103], v[132:135]
    ds_read_b128 v[84:87], v0 offset:41984
    v_fma_f32 v186, v171, v32, s65
    v_mfma_f32_16x16x32_bf16 v[136:139], a[156:159], v[104:107], v[136:139]
    ds_read_b128 v[88:91], v0 offset:58368
    s_waitcnt lgkmcnt(6)
    v_mfma_f32_16x16x32_bf16 v[124:127], a[160:163], v[108:111], v[124:127]
    ds_read_b128 v[92:95], v0 offset:10240
    v_fma_f32 v187, v171, v33, s65
    v_mfma_f32_16x16x32_bf16 v[128:131], a[160:163], v[112:115], v[128:131]
    ds_read_b128 v[96:99], v0 offset:26624
    s_waitcnt lgkmcnt(6)
    v_mfma_f32_16x16x32_bf16 v[132:135], a[160:163], v[116:119], v[132:135]
    ds_read_b128 v[100:103], v0 offset:43008
    v_mfma_f32_16x16x32_bf16 v[136:139], a[160:163], v[120:123], v[136:139]
    ds_read_b128 v[104:107], v0 offset:59392
    s_waitcnt lgkmcnt(6)
    v_mfma_f32_16x16x32_bf16 v[124:127], a[164:167], v[76:79], v[124:127]
    ds_read_b128 v[108:111], v0 offset:11264
    v_mfma_f32_16x16x32_bf16 v[128:131], a[164:167], v[80:83], v[128:131]
    ds_read_b128 v[112:115], v0 offset:27648
    s_waitcnt lgkmcnt(6)
    v_mfma_f32_16x16x32_bf16 v[132:135], a[164:167], v[84:87], v[132:135]
    ds_read_b128 v[116:119], v0 offset:44032
    v_mfma_f32_16x16x32_bf16 v[136:139], a[164:167], v[88:91], v[136:139]
    ds_read_b128 v[120:123], v0 offset:60416
    s_waitcnt lgkmcnt(6)
    v_mfma_f32_16x16x32_bf16 v[124:127], a[168:171], v[92:95], v[124:127]
    ds_read_b128 v[76:79], v0 offset:12288
    buffer_load_dwordx4 v[140:143], v1, s[28:31], s9 offen offset:0 sc1
    v_mfma_f32_16x16x32_bf16 v[128:131], a[168:171], v[96:99], v[128:131]
    ds_read_b128 v[80:83], v0 offset:28672
    s_waitcnt lgkmcnt(6)
    v_mfma_f32_16x16x32_bf16 v[132:135], a[168:171], v[100:103], v[132:135]
    ds_read_b128 v[84:87], v0 offset:45056
    buffer_load_dwordx4 v[144:147], v1, s[28:31], s9 offen offset:1024 sc1
    v_mfma_f32_16x16x32_bf16 v[136:139], a[168:171], v[104:107], v[136:139]
    ds_read_b128 v[88:91], v0 offset:61440
    s_waitcnt lgkmcnt(6)
    v_mfma_f32_16x16x32_bf16 v[124:127], a[172:175], v[108:111], v[124:127]
    ds_read_b128 v[92:95], v0 offset:13312
    buffer_load_dwordx4 v[148:151], v1, s[28:31], s9 offen offset:2048 sc1
    v_mfma_f32_16x16x32_bf16 v[128:131], a[172:175], v[112:115], v[128:131]
    ds_read_b128 v[96:99], v0 offset:29696
    s_waitcnt lgkmcnt(6)
    v_mfma_f32_16x16x32_bf16 v[132:135], a[172:175], v[116:119], v[132:135]
    ds_read_b128 v[100:103], v0 offset:46080
    buffer_load_dwordx4 v[152:155], v1, s[28:31], s9 offen offset:3072 sc1
    v_mfma_f32_16x16x32_bf16 v[136:139], a[172:175], v[120:123], v[136:139]
    ds_read_b128 v[104:107], v0 offset:62464
    s_waitcnt lgkmcnt(6)
    v_mfma_f32_16x16x32_bf16 v[124:127], a[176:179], v[76:79], v[124:127]
    ds_read_b128 v[108:111], v0 offset:14336
    buffer_load_dwordx4 v[156:159], v191, s[28:31], s10 offen offset:0 sc1
    v_mfma_f32_16x16x32_bf16 v[128:131], a[176:179], v[80:83], v[128:131]
    ds_read_b128 v[112:115], v0 offset:30720
    s_waitcnt lgkmcnt(6)
    v_mfma_f32_16x16x32_bf16 v[132:135], a[176:179], v[84:87], v[132:135]
    ds_read_b128 v[116:119], v0 offset:47104
    buffer_load_dwordx4 v[160:163], v191, s[28:31], s10 offen offset:256 sc1
    v_mfma_f32_16x16x32_bf16 v[136:139], a[176:179], v[88:91], v[136:139]
    ds_read_b128 v[120:123], v0 offset:63488
    s_waitcnt lgkmcnt(6)
    v_mfma_f32_16x16x32_bf16 v[124:127], a[180:183], v[92:95], v[124:127]
    ds_read_b128 v[76:79], v0 offset:15360
    v_mfma_f32_16x16x32_bf16 v[128:131], a[180:183], v[96:99], v[128:131]
    ds_read_b128 v[80:83], v0 offset:31744
    s_waitcnt lgkmcnt(6)
    v_mfma_f32_16x16x32_bf16 v[132:135], a[180:183], v[100:103], v[132:135]
    ds_read_b128 v[84:87], v0 offset:48128
    v_mfma_f32_16x16x32_bf16 v[136:139], a[180:183], v[104:107], v[136:139]
    ds_read_b128 v[88:91], v0 offset:64512
    s_waitcnt lgkmcnt(6)
    v_mfma_f32_16x16x32_bf16 v[124:127], a[184:187], v[108:111], v[124:127]
    v_mfma_f32_16x16x32_bf16 v[128:131], a[184:187], v[112:115], v[128:131]
    s_waitcnt lgkmcnt(4)
    v_mfma_f32_16x16x32_bf16 v[132:135], a[184:187], v[116:119], v[132:135]
    v_mfma_f32_16x16x32_bf16 v[136:139], a[184:187], v[120:123], v[136:139]
    s_waitcnt lgkmcnt(2)
    v_mfma_f32_16x16x32_bf16 v[124:127], a[188:191], v[76:79], v[124:127]
    v_mfma_f32_16x16x32_bf16 v[128:131], a[188:191], v[80:83], v[128:131]
    s_waitcnt lgkmcnt(0)
    v_mfma_f32_16x16x32_bf16 v[132:135], a[188:191], v[84:87], v[132:135]
    v_mfma_f32_16x16x32_bf16 v[136:139], a[188:191], v[88:91], v[136:139]
    s_nop 3
    v_pk_fma_f32 v[124:125], v[124:125], v[164:165], v[172:173] op_sel_hi:[1,0,1]
    v_pk_fma_f32 v[126:127], v[126:127], v[164:165], v[174:175] op_sel_hi:[1,0,1]
    v_pk_mul_f32 v[76:77], v[124:125], s[84:85]
    v_pk_mul_f32 v[78:79], v[126:127], s[84:85]
    v_exp_f32_e64 v76, v76 clamp
    v_exp_f32_e64 v77, v77 clamp
    v_exp_f32_e64 v78, v78 clamp
    v_exp_f32_e64 v79, v79 clamp
    v_max_f32 v124, s65, v124
    v_max_f32 v125, s65, v125
    v_max_f32 v126, s65, v126
    v_max_f32 v127, s65, v127
    v_pk_add_f32 v[124:125], v[124:125], v[76:77]
    v_pk_add_f32 v[126:127], v[126:127], v[78:79]
    v_cvt_pk_bf16_f32 v84, v124, v125
    v_cvt_pk_bf16_f32 v85, v126, v127
    v_pk_fma_f32 v[128:129], v[128:129], v[166:167], v[176:177] op_sel_hi:[1,0,1]
    v_pk_fma_f32 v[130:131], v[130:131], v[166:167], v[178:179] op_sel_hi:[1,0,1]
    v_pk_mul_f32 v[76:77], v[128:129], s[84:85]
    v_pk_mul_f32 v[78:79], v[130:131], s[84:85]
    v_exp_f32_e64 v76, v76 clamp
    v_exp_f32_e64 v77, v77 clamp
    v_exp_f32_e64 v78, v78 clamp
    v_exp_f32_e64 v79, v79 clamp
    v_max_f32 v128, s65, v128
    v_max_f32 v129, s65, v129
    v_max_f32 v130, s65, v130
    v_max_f32 v131, s65, v131
    v_pk_add_f32 v[128:129], v[128:129], v[76:77]
    v_pk_add_f32 v[130:131], v[130:131], v[78:79]
    v_cvt_pk_bf16_f32 v86, v128, v129
    v_cvt_pk_bf16_f32 v87, v130, v131
    s_cmp_eq_u32 s48, 0
    s_cbranch_scc1 L_slowst_73
    buffer_store_dwordx2 v[84:85], v8, s[28:31], s36 offen offset:0
    buffer_store_dwordx2 v[86:87], v8, s[28:31], s36 offen offset:256
L_joinst_74:
    v_pk_fma_f32 v[132:133], v[132:133], v[168:169], v[180:181] op_sel_hi:[1,0,1]
    v_pk_fma_f32 v[134:135], v[134:135], v[168:169], v[182:183] op_sel_hi:[1,0,1]
    v_pk_mul_f32 v[76:77], v[132:133], s[84:85]
    v_pk_mul_f32 v[78:79], v[134:135], s[84:85]
    v_exp_f32_e64 v76, v76 clamp
    v_exp_f32_e64 v77, v77 clamp
    v_exp_f32_e64 v78, v78 clamp
    v_exp_f32_e64 v79, v79 clamp
    v_max_f32 v132, s65, v132
    v_max_f32 v133, s65, v133
    v_max_f32 v134, s65, v134
    v_max_f32 v135, s65, v135
    v_pk_add_f32 v[132:133], v[132:133], v[76:77]
    v_pk_add_f32 v[134:135], v[134:135], v[78:79]
    v_cvt_pk_bf16_f32 v88, v132, v133
    v_cvt_pk_bf16_f32 v89, v134, v135
    v_pk_fma_f32 v[136:137], v[136:137], v[170:171], v[184:185] op_sel_hi:[1,0,1]
    v_pk_fma_f32 v[138:139], v[138:139], v[170:171], v[186:187] op_sel_hi:[1,0,1]
    v_pk_mul_f32 v[76:77], v[136:137], s[84:85]
    v_pk_mul_f32 v[78:79], v[138:139], s[84:85]
    v_exp_f32_e64 v76, v76 clamp
    v_exp_f32_e64 v77, v77 clamp
    v_exp_f32_e64 v78, v78 clamp
    v_exp_f32_e64 v79, v79 clamp
    v_max_f32 v136, s65, v136
    v_max_f32 v137, s65, v137
    v_max_f32 v138, s65, v138
    v_max_f32 v139, s65, v139
    v_pk_add_f32 v[136:137], v[136:137], v[76:77]
    v_pk_add_f32 v[138:139], v[138:139], v[78:79]
    v_cvt_pk_bf16_f32 v90, v136, v137
    v_cvt_pk_bf16_f32 v91, v138, v139
    s_cmp_eq_u32 s48, 0
    s_cbranch_scc1 L_slowst_75
    buffer_store_dwordx2 v[88:89], v8, s[28:31], s37 offen offset:0
    buffer_store_dwordx2 v[90:91], v8, s[28:31], s37 offen offset:256
L_joinst_76:
    s_waitcnt vmcnt(9)
    v_max3_u32 v168, v140, v141, v142
    s_waitcnt vmcnt(8)
    v_max3_u32 v168, v168, v143, v144
    v_max3_u32 v168, v168, v145, v146
    s_waitcnt vmcnt(7)
    v_max3_u32 v168, v168, v147, v148
    v_max3_u32 v168, v168, v149, v150
    s_waitcnt vmcnt(6)
    v_max3_u32 v168, v168, v151, v152
    v_max3_u32 v168, v168, v153, v154
    s_waitcnt vmcnt(5)
    v_max3_u32 v168, v168, v155, v156
    v_max3_u32 v168, v168, v157, v158
    s_waitcnt vmcnt(4)
    v_max3_u32 v168, v168, v159, v160
    v_max3_u32 v168, v168, v161, v162
    v_max_u32_e64 v168, v168, v163
    v_cmp_eq_u32 vcc, -1, v168
    s_nop 0
    s_cbranch_vccz L_latedone_78
    s_mov_b32 s50, s49
L_late_77:
    buffer_load_dwordx4 v[140:143], v1, s[28:31], s9 offen offset:0 sc1
    buffer_load_dwordx4 v[144:147], v1, s[28:31], s9 offen offset:1024 sc1
    buffer_load_dwordx4 v[148:151], v1, s[28:31], s9 offen offset:2048 sc1
    buffer_load_dwordx4 v[152:155], v1, s[28:31], s9 offen offset:3072 sc1
    buffer_load_dwordx4 v[156:159], v191, s[28:31], s10 offen offset:0 sc1
    buffer_load_dwordx4 v[160:163], v191, s[28:31], s10 offen offset:256 sc1
    s_waitcnt vmcnt(5)
    v_max3_u32 v168, v140, v141, v142
    s_waitcnt vmcnt(4)
    v_max3_u32 v168, v168, v143, v144
    v_max3_u32 v168, v168, v145, v146
    s_waitcnt vmcnt(3)
    v_max3_u32 v168, v168, v147, v148
    v_max3_u32 v168, v168, v149, v150
    s_waitcnt vmcnt(2)
    v_max3_u32 v168, v168, v151, v152
    v_max3_u32 v168, v168, v153, v154
    s_waitcnt vmcnt(1)
    v_max3_u32 v168, v168, v155, v156
    v_max3_u32 v168, v168, v157, v158
    s_waitcnt vmcnt(0)
    v_max3_u32 v168, v168, v159, v160
    v_max3_u32 v168, v168, v161, v162
    v_max_u32 v168, v168, v163
    v_cmp_eq_u32 vcc, -1, v168
    s_nop 0
    s_cbranch_vccz L_latedone_78
    s_sub_u32 s50, s50, 1
    s_cbranch_scc0 L_late_77
    s_mov_b32 s49, 0
    s_or_b32 s72, s72, 32
L_latedone_78:
    v_pk_add_f32 v[156:157], v[156:157], v[160:161]
    v_pk_add_f32 v[158:159], v[158:159], v[162:163]
    v_mfma_f32_16x16x32_bf16 v[164:167], v[20:23], v[140:143], 0
    v_add_f32_dpp v156, v156, v156 row_ror:8 row_mask:0xf bank_mask:0xf
    v_add_f32_dpp v157, v157, v157 row_ror:8 row_mask:0xf bank_mask:0xf
    v_add_f32_dpp v158, v158, v158 row_ror:8 row_mask:0xf bank_mask:0xf
    v_add_f32_dpp v159, v159, v159 row_ror:8 row_mask:0xf bank_mask:0xf
    v_mfma_f32_16x16x32_bf16 v[164:167], v[20:23], v[144:147], v[164:167]
    v_add_f32_dpp v156, v156, v156 row_ror:4 row_mask:0xf bank_mask:0xf
    v_add_f32_dpp v157, v157, v157 row_ror:4 row_mask:0xf bank_mask:0xf
    v_add_f32_dpp v158, v158, v158 row_ror:4 row_mask:0xf bank_mask:0xf
    v_add_f32_dpp v159, v159, v159 row_ror:4 row_mask:0xf bank_mask:0xf
    v_mfma_f32_16x16x32_bf16 v[164:167], v[20:23], v[148:151], v[164:167]
    v_add_f32_dpp v156, v156, v156 row_ror:2 row_mask:0xf bank_mask:0xf
    v_add_f32_dpp v157, v157, v157 row_ror:2 row_mask:0xf bank_mask:0xf
    v_add_f32_dpp v158, v158, v158 row_ror:2 row_mask:0xf bank_mask:0xf
    v_add_f32_dpp v159, v159, v159 row_ror:2 row_mask:0xf bank_mask:0xf
    v_mfma_f32_16x16x32_bf16 v[164:167], v[20:23], v[152:155], v[164:167]
    v_add_f32_dpp v156, v156, v156 row_ror:1 row_mask:0xf bank_mask:0xf
    v_add_f32_dpp v157, v157, v157 row_ror:1 row_mask:0xf bank_mask:0xf
    v_add_f32_dpp v158, v158, v158 row_ror:1 row_mask:0xf bank_mask:0xf
    v_add_f32_dpp v159, v159, v159 row_ror:1 row_mask:0xf bank_mask:0xf
    v_cvt_pk_bf16_f32 v156, v156, v157
    v_cvt_pk_bf16_f32 v157, v158, v159
    s_nop 1
    v_add_f32_dpp v164, v164, v164 row_ror:8 row_mask:0xf bank_mask:0xf
    v_add_f32_dpp v165, v165, v165 row_ror:8 row_mask:0xf bank_mask:0xf
    v_add_f32_dpp v166, v166, v166 row_ror:8 row_mask:0xf bank_mask:0xf
    v_add_f32_dpp v167, v167, v167 row_ror:8 row_mask:0xf bank_mask:0xf
    v_cvt_pk_bf16_f32 v164, v164, v165
    v_cvt_pk_bf16_f32 v165, v166, v167
    v_cndmask_b32 v164, v164, v156, s[16:17]
    v_cndmask_b32 v165, v165, v157, s[16:17]
    v_min_u32 v164, -2, v164
    v_min_u32_e64 v165, -2, v165
    s_cmp_eq_u32 s48, 0
    s_cbranch_scc1 L_slowst_80
    s_mov_b32 exec_lo, 0x00ff00ff
    s_mov_b32 exec_hi, 0x0000ffff
    buffer_store_dwordx2 v[164:165], v10, s[28:31], s11 offen
    s_mov_b64 exec, -1
L_joinst_81:
    buffer_load_dwordx4 v[76:79], v1, s[28:31], s14 offen offset:0 sc1
    buffer_load_dwordx4 v[80:83], v1, s[28:31], s14 offen offset:1024 sc1
    buffer_load_dwordx4 v[84:87], v1, s[28:31], s14 offen offset:2048 sc1
    buffer_load_dwordx4 v[88:91], v1, s[28:31], s14 offen offset:3072 sc1
    s_waitcnt vmcnt(4)
    buffer_load_dwordx4 v[108:111], v1, s[28:31], s12 offen offset:0 sc1
    buffer_load_dwordx4 v[112:115], v1, s[28:31], s12 offen offset:1024 sc1
    buffer_load_dwordx4 v[116:119], v1, s[28:31], s12 offen offset:2048 sc1
    buffer_load_dwordx4 v[120:123], v1, s[28:31], s12 offen offset:3072 sc1
    s_barrier
    s_lshl_b32 s52, s46, 12
    v_add_u32 v185, 0x20000, v1
    v_add_u32 v184, s52, v185
    s_add_u32 s53, s52, 0x1000
    s_and_b32 s53, s53, 0x3fff
    v_add_u32 v180, s53, v185
    s_add_u32 s53, s52, 0x2000
    s_and_b32 s53, s53, 0x3fff
    v_add_u32 v181, s53, v185
    s_add_u32 s53, s52, 0x3000
    s_and_b32 s53, s53, 0x3fff
    v_add_u32 v182, s53, v185
    s_waitcnt vmcnt(6)
    v_or3_b32 v187, v77, v79, v81
    s_waitcnt vmcnt(5)
    v_or3_b32 v187, v187, v83, v85
    s_waitcnt vmcnt(4)
    v_or3_b32 v187, v187, v87, v89
    v_or_b32 v187, v187, v91
    v_ashrrev_i32 v187, 31, v187
    s_waitcnt vmcnt(3)
    v_max3_u32 v186, v187, v108, v110
    s_waitcnt vmcnt(2)
    v_max3_u32 v186, v186, v112, v114
    s_waitcnt vmcnt(1)
    v_max3_u32 v186, v186, v116, v118
    s_waitcnt vmcnt(0)
    v_max3_u32 v186, v186, v120, v122
    v_cmp_eq_u32 vcc, -1, v186
    s_nop 0
    s_cbranch_vccz L_latedone_83
    s_mov_b32 s50, s49
L_late_82:
    buffer_load_dwordx4 v[76:79], v1, s[28:31], s14 offen offset:0 sc1
    buffer_load_dwordx4 v[80:83], v1, s[28:31], s14 offen offset:1024 sc1
    buffer_load_dwordx4 v[84:87], v1, s[28:31], s14 offen offset:2048 sc1
    buffer_load_dwordx4 v[88:91], v1, s[28:31], s14 offen offset:3072 sc1
    buffer_load_dwordx4 v[108:111], v1, s[28:31], s12 offen offset:0 sc1
    buffer_load_dwordx4 v[112:115], v1, s[28:31], s12 offen offset:1024 sc1
    buffer_load_dwordx4 v[116:119], v1, s[28:31], s12 offen offset:2048 sc1
    buffer_load_dwordx4 v[120:123], v1, s[28:31], s12 offen offset:3072 sc1
    s_waitcnt vmcnt(6)
    v_or3_b32 v187, v77, v79, v81
    s_waitcnt vmcnt(5)
    v_or3_b32 v187, v187, v83, v85
    s_waitcnt vmcnt(4)
    v_or3_b32 v187, v187, v87, v89
    v_or_b32 v187, v187, v91
    v_ashrrev_i32 v187, 31, v187
    s_waitcnt vmcnt(3)
    v_max3_u32 v186, v187, v108, v110
    s_waitcnt vmcnt(2)
    v_max3_u32 v186, v186, v112, v114
    s_waitcnt vmcnt(1)
    v_max3_u32 v186, v186, v116, v118
    s_waitcnt vmcnt(0)
    v_max3_u32 v186, v186, v120, v122
    v_cmp_eq_u32 vcc, -1, v186
    s_nop 0
    s_cbranch_vccz L_latedone_83
    s_sub_u32 s50, s50, 1
    s_cbranch_scc0 L_late_82
    s_mov_b32 s49, 0
    s_or_b32 s72, s72, 256
L_latedone_83:
    v_mfma_f32_32x32x16_bf16 v[140:155], v[108:111], v[76:79], 0
    v_mfma_f32_32x32x16_bf16 v[156:171], v[112:115], v[80:83], 0
    buffer_load_dwordx4 v[92:95], v1, s[28:31], s15 offen offset:0 sc1
    buffer_load_dwordx4 v[96:99], v1, s[28:31], s15 offen offset:1024 sc1
    buffer_load_dwordx4 v[100:103], v1, s[28:31], s15 offen offset:2048 sc1
    buffer_load_dwordx4 v[104:107], v1, s[28:31], s15 offen offset:3072 sc1
    s_nop 6
    v_add_f32 v148, s65, v148
    v_rcp_f32 v148, v148
    v_add_f32 v164, s65, v164
    v_rcp_f32_e64 v164, v164
    v_pk_mul_f32 v[140:141], v[140:141], v[148:149] op_sel_hi:[1,0]
    v_pk_mul_f32 v[142:143], v[142:143], v[148:149] op_sel_hi:[1,0]
    v_pk_mul_f32 v[144:145], v[144:145], v[148:149] op_sel_hi:[1,0]
    v_pk_mul_f32 v[146:147], v[146:147], v[148:149] op_sel_hi:[1,0]
    v_cvt_pk_bf16_f32 v76, v140, v141
    v_cvt_pk_bf16_f32 v77, v142, v143
    v_cvt_pk_bf16_f32 v78, v144, v145
    v_cvt_pk_bf16_f32 v79, v146, v147
    ds_write_b128 v184, v[76:79] offset:0
    v_mfma_f32_32x32x16_bf16 v[140:155], v[116:119], v[84:87], 0
    v_mul_f32 v156, v156, v164
    v_mul_f32 v157, v157, v164
    v_mul_f32 v158, v158, v164
    v_mul_f32 v159, v159, v164
    v_mul_f32 v160, v160, v164
    v_mul_f32 v161, v161, v164
    v_mul_f32 v162, v162, v164
    v_mul_f32 v163, v163, v164
    v_cvt_pk_bf16_f32 v80, v156, v157
    v_cvt_pk_bf16_f32 v81, v158, v159
    v_cvt_pk_bf16_f32 v82, v160, v161
    v_cvt_pk_bf16_f32 v83, v162, v163
    ds_write_b128 v184, v[80:83] offset:1024
    v_mfma_f32_32x32x16_bf16 v[156:171], v[120:123], v[88:91], 0
    buffer_load_dwordx4 v[124:127], v1, s[28:31], s13 offen offset:0 sc1
    buffer_load_dwordx4 v[128:131], v1, s[28:31], s13 offen offset:1024 sc1
    buffer_load_dwordx4 v[132:135], v1, s[28:31], s13 offen offset:2048 sc1
    buffer_load_dwordx4 v[136:139], v1, s[28:31], s13 offen offset:3072 sc1
    v_add_f32 v148, s65, v148
    v_rcp_f32 v148, v148
    s_nop 5
    v_add_f32 v164, s65, v164
    v_rcp_f32 v164, v164
    v_mfma_f32_32x32x16_bf16 v[34:49], a[192:195], v[76:79], v[34:49]
    v_mul_f32 v140, v140, v148
    v_mul_f32 v141, v141, v148
    v_mul_f32 v142, v142, v148
    v_mul_f32 v143, v143, v148
    v_mul_f32 v144, v144, v148
    v_mul_f32 v145, v145, v148
    v_mul_f32 v146, v146, v148
    v_mul_f32_e64 v147, v147, v148
    v_cvt_pk_bf16_f32 v84, v140, v141
    v_cvt_pk_bf16_f32 v85, v142, v143
    v_cvt_pk_bf16_f32 v86, v144, v145
    v_cvt_pk_bf16_f32 v87, v146, v147
    ds_write_b128 v184, v[84:87] offset:2048
    v_mfma_f32_32x32x16_bf16 v[34:49], a[196:199], v[80:83], v[34:49]
    v_mul_f32 v156, v156, v164
    v_mul_f32 v157, v157, v164
    v_mul_f32 v158, v158, v164
    v_mul_f32 v159, v159, v164
    v_mul_f32 v160, v160, v164
    v_mul_f32 v161, v161, v164
    v_mul_f32 v162, v162, v164
    v_mul_f32 v163, v163, v164
    v_cvt_pk_bf16_f32 v88, v156, v157
    v_cvt_pk_bf16_f32 v89, v158, v159
    v_cvt_pk_bf16_f32 v90, v160, v161
    v_cvt_pk_bf16_f32 v91, v162, v163
    ds_write_b128 v184, v[88:91] offset:3072
    v_mfma_f32_32x32x16_bf16 v[34:49], a[200:203], v[84:87], v[34:49]
    s_waitcnt lgkmcnt(0)
    s_barrier
    ds_read_b128 v[108:111], v180 offset:0
    ds_read_b128 v[112:115], v180 offset:1024
    ds_read_b128 v[116:119], v180 offset:2048
    ds_read_b128 v[120:123], v180 offset:3072
    ds_read_b128 v[172:175], v181 offset:0
    ds_read_b128 v[176:179], v181 offset:1024
    v_mfma_f32_32x32x16_bf16 v[34:49], a[204:207], v[88:91], v[34:49]
    s_waitcnt vmcnt(6)
    v_or3_b32 v187, v93, v95, v97
    s_waitcnt vmcnt(5)
    v_or3_b32 v187, v187, v99, v101
    s_waitcnt vmcnt(4)
    v_or3_b32 v187, v187, v103, v105
    v_or_b32 v187, v187, v107
    v_ashrrev_i32 v187, 31, v187
    s_waitcnt vmcnt(3)
    v_max3_u32 v186, v187, v124, v126
    s_waitcnt vmcnt(2)
    v_max3_u32 v186, v186, v128, v130
    s_waitcnt vmcnt(1)
    v_max3_u32 v186, v186, v132, v134
    s_waitcnt vmcnt(0)
    v_max3_u32 v186, v186, v136, v138
    v_cmp_eq_u32 vcc, -1, v186
    s_nop 0
    s_cbranch_vccnz L_retry_85
L_retryjoin_86:
    s_cmp_lg_u32 s74, 0
    s_cbranch_scc1 L_wb_88
    buffer_wbl2 sc1
L_wb_88:
    v_mfma_f32_32x32x16_bf16 v[140:155], v[124:127], v[92:95], 0
    v_mfma_f32_32x32x16_bf16 v[156:171], v[128:131], v[96:99], 0
    s_waitcnt lgkmcnt(5)
    v_mfma_f32_32x32x16_bf16 v[34:49], a[208:211], v[108:111], v[34:49]
    s_nop 8
    v_add_f32 v148, s65, v148
    v_rcp_f32 v148, v148
    s_nop 0
    v_mul_f32 v140, v140, v148
    v_mul_f32 v141, v141, v148
    v_mul_f32 v142, v142, v148
    s_waitcnt lgkmcnt(4)
    v_mfma_f32_32x32x16_bf16 v[34:49], a[212:215], v[112:115], v[34:49]
    ds_read_b128 v[108:111], v181 offset:2048
    v_mul_f32 v143, v143, v148
    v_mul_f32 v144, v144, v148
    v_mul_f32 v145, v145, v148
    v_mul_f32 v146, v146, v148
    v_mul_f32_e64 v147, v147, v148
    s_waitcnt lgkmcnt(4)
    v_mfma_f32_32x32x16_bf16 v[34:49], a[216:219], v[116:119], v[34:49]
    ds_read_b128 v[112:115], v181 offset:3072
    v_cvt_pk_bf16_f32 v92, v140, v141
    v_cvt_pk_bf16_f32 v93, v142, v143
    v_cvt_pk_bf16_f32 v94, v144, v145
    v_cvt_pk_bf16_f32 v95, v146, v147
    v_mfma_f32_32x32x16_bf16 v[140:155], v[132:135], v[100:103], 0
    ds_write_b128 v184, v[92:95] offset:16384
    v_add_f32 v164, s65, v164
    v_rcp_f32 v164, v164
    s_waitcnt lgkmcnt(3)
    v_mfma_f32_32x32x16_bf16 v[34:49], a[220:223], v[120:123], v[34:49]
    ds_read_b128 v[116:119], v182 offset:0
    v_mul_f32 v156, v156, v164
    v_mul_f32 v157, v157, v164
    v_mul_f32 v158, v158, v164
    v_mul_f32 v159, v159, v164
    v_mul_f32 v160, v160, v164
    v_mfma_f32_32x32x16_bf16 v[34:49], a[224:227], v[172:175], v[34:49]
    ds_read_b128 v[120:123], v182 offset:1024
    v_mul_f32 v161, v161, v164
    v_mul_f32 v162, v162, v164
    v_mul_f32_e64 v163, v163, v164
    v_cvt_pk_bf16_f32 v96, v156, v157
    v_cvt_pk_bf16_f32 v97, v158, v159
    v_mfma_f32_32x32x16_bf16 v[34:49], a[228:231], v[176:179], v[34:49]
    ds_read_b128 v[172:175], v182 offset:2048
    v_cvt_pk_bf16_f32 v98, v160, v161
    v_cvt_pk_bf16_f32 v99, v162, v163
    s_waitcnt lgkmcnt(2)
    v_mfma_f32_32x32x16_bf16 v[34:49], a[232:235], v[108:111], v[34:49]
    ds_read_b128 v[176:179], v182 offset:3072
    ds_write_b128 v184, v[96:99] offset:17408
    v_add_f32 v148, s65, v148
    v_rcp_f32 v148, v148
    v_mfma_f32_32x32x16_bf16 v[156:171], v[136:139], v[104:107], 0
    v_mul_f32 v140, v140, v148
    v_mul_f32 v141, v141, v148
    v_mul_f32 v142, v142, v148
    v_mul_f32 v143, v143, v148
    v_mul_f32 v144, v144, v148
    v_mul_f32 v145, v145, v148
    v_mfma_f32_32x32x16_bf16 v[34:49], a[236:239], v[112:115], v[34:49]
    v_mul_f32 v146, v146, v148
    v_mul_f32_e64 v147, v147, v148
    v_cvt_pk_bf16_f32 v100, v140, v141
    v_cvt_pk_bf16_f32 v101, v142, v143
    v_cvt_pk_bf16_f32 v102, v144, v145
    v_cvt_pk_bf16_f32 v103, v146, v147
    v_mfma_f32_32x32x16_bf16 v[34:49], a[240:243], v[116:119], v[34:49]
    ds_write_b128 v184, v[100:103] offset:18432
    v_add_f32 v164, s65, v164
    v_rcp_f32 v164, v164
    s_waitcnt lgkmcnt(2)
    v_mfma_f32_32x32x16_bf16 v[34:49], a[244:247], v[120:123], v[34:49]
    v_mul_f32 v156, v156, v164
    v_mul_f32 v157, v157, v164
    v_mul_f32 v158, v158, v164
    v_mul_f32 v159, v159, v164
    v_mul_f32 v160, v160, v164
    v_mul_f32 v161, v161, v164
    v_mfma_f32_32x32x16_bf16 v[34:49], a[248:251], v[172:175], v[34:49]
    v_mul_f32 v162, v162, v164
    v_mul_f32_e64 v163, v163, v164
    v_cvt_pk_bf16_f32 v104, v156, v157
    v_cvt_pk_bf16_f32 v105, v158, v159
    v_cvt_pk_bf16_f32 v106, v160, v161
    v_cvt_pk_bf16_f32 v107, v162, v163
    v_mfma_f32_32x32x16_bf16 v[34:49], a[252:255], v[176:179], v[34:49]
    ds_write_b128 v184, v[104:107] offset:19456
    v_mfma_f32_32x32x16_bf16 v[34:49], v[192:195], v[92:95], v[34:49]
    v_mfma_f32_32x32x16_bf16 v[34:49], v[196:199], v[96:99], v[34:49]
    s_waitcnt lgkmcnt(0)
    s_barrier
    ds_read_b128 v[108:111], v180 offset:16384
    ds_read_b128 v[112:115], v180 offset:17408
    ds_read_b128 v[116:119], v180 offset:18432
    ds_read_b128 v[120:123], v180 offset:19456
    ds_read_b128 v[172:175], v181 offset:16384
    ds_read_b128 v[176:179], v181 offset:17408
    v_mfma_f32_32x32x16_bf16 v[34:49], v[200:203], v[100:103], v[34:49]
    v_mfma_f32_32x32x16_bf16 v[34:49], v[204:207], v[104:107], v[34:49]
    s_waitcnt lgkmcnt(5)
    v_mfma_f32_32x32x16_bf16 v[34:49], v[208:211], v[108:111], v[34:49]
    s_lshl_b32 s54, s46, 11
    v_and_b32 v54, 0x1f0, v1
    v_lshl_add_u32 v50, v54, 2, s54
    v_lshrrev_b32 v54, 1, v54
    v_lshrrev_b32 v55, 4, v1
    v_xor_b32 v54, v54, v55
    s_waitcnt lgkmcnt(4)
    v_mfma_f32_32x32x16_bf16 v[34:49], v[212:215], v[112:115], v[34:49]
    ds_read_b128 v[108:111], v181 offset:18432
    v_and_b32 v54, 0x30, v54
    v_and_b32 v55, 0x10, v55
    v_xor_b32 v54, v54, v55
    v_add_u32 v50, v50, v54
    s_waitcnt lgkmcnt(3)
    v_mfma_f32_32x32x16_bf16 v[34:49], v[216:219], v[116:119], v[34:49]
    ds_read_b128 v[112:115], v181 offset:19456
    v_xor_b32 v51, 16, v50
    v_add_u32 v52, s54, v1
    v_lshrrev_b32 v54, 3, v1
    v_xor_b32 v54, v54, v1
    v_and_b32 v54, 0x30, v54
    v_mfma_f32_32x32x16_bf16 v[34:49], v[220:223], v[120:123], v[34:49]
    ds_read_b128 v[116:119], v182 offset:16384
    v_bfe_u32 v55, v1, 6, 3
    v_lshl_add_u32 v54, v55, 12, v54
    v_bfe_u32 v55, v1, 9, 1
    v_lshl_add_u32 v54, v55, 11, v54
    s_waitcnt lgkmcnt(3)
    v_mfma_f32_32x32x16_bf16 v[34:49], v[224:227], v[172:175], v[34:49]
    ds_read_b128 v[120:123], v182 offset:17408
    s_lshl_b32 s54, s87, 15
    s_lshl_b32 s55, s62, 6
    s_add_u32 s54, s54, s55
    v_add_u32 v53, s54, v54
    v_mfma_f32_32x32x16_bf16 v[34:49], v[228:231], v[176:179], v[34:49]
    ds_read_b128 v[172:175], v182 offset:18432
    s_waitcnt lgkmcnt(3)
    v_mfma_f32_32x32x16_bf16 v[34:49], v[232:235], v[108:111], v[34:49]
    ds_read_b128 v[176:179], v182 offset:19456
    v_mfma_f32_32x32x16_bf16 v[34:49], v[236:239], v[112:115], v[34:49]
    s_waitcnt lgkmcnt(2)
    v_mfma_f32_32x32x16_bf16 v[34:49], v[240:243], v[116:119], v[34:49]
    v_mfma_f32_32x32x16_bf16 v[34:49], v[244:247], v[120:123], v[34:49]
    s_waitcnt lgkmcnt(0)
    v_mfma_f32_32x32x16_bf16 v[34:49], v[248:251], v[172:175], v[34:49]
    v_mfma_f32_32x32x16_bf16 v[34:49], v[252:255], v[176:179], v[34:49]
    s_nop 11
    v_cvt_pk_bf16_f32 v76, v34, v35
    v_cvt_pk_bf16_f32 v77, v36, v37
    v_cvt_pk_bf16_f32 v78, v38, v39
    v_cvt_pk_bf16_f32 v79, v40, v41
    ds_write_b128 v50, v[76:79]
    v_cvt_pk_bf16_f32 v80, v42, v43
    v_cvt_pk_bf16_f32 v81, v44, v45
    v_cvt_pk_bf16_f32 v82, v46, v47
    v_cvt_pk_bf16_f32 v83, v48, v49
    ds_write_b128 v51, v[80:83]
    ds_read_b128 v[84:87], v52 offset:0
    ds_read_b128 v[88:91], v52 offset:1024
    s_waitcnt lgkmcnt(1)
    buffer_store_dwordx4 v[84:87], v53, s[32:35], 0 offen offset:0 sc1
    s_waitcnt lgkmcnt(0)
    buffer_store_dwordx4 v[88:91], v53, s[32:35], 0 offen offset:1024 sc1
    s_or_b32 s52, s2, s46
    s_cmp_lg_u32 s52, 0
    s_cbranch_scc1 L_epoch_89
    s_mov_b32 s52, 0
    s_mov_b64 exec, 1
    buffer_store_dwordx2 v[18:19], off, s[28:31], s52 offset:0 sc1
    s_mov_b64 exec, -1
L_epoch_89:
    s_endpgm
L_h1slow_7:
    s_lshl_b32 s53, s44, 8
    s_add_u32 s53, s53, 0x2000
    s_lshl_b32 s54, s45, 3
    s_add_u32 s54, s54, s53
    s_mov_b64 exec, 1
    buffer_store_dwordx2 v[18:19], off, s[28:31], s54 offset:0 sc1
    s_mov_b64 exec, -1
    s_mov_b32 s50, s49
L_h1slowtop_8:
    buffer_load_dwordx2 v[120:121], v124, s[28:31], s52 offen sc1
    buffer_load_dwordx2 v[128:129], v124, s[28:31], s53 offen sc1
    s_mov_b32 s48, 1
    s_waitcnt vmcnt(1)
    v_cmp_ne_u64 vcc, s[56:57], v[120:121]
    s_nop 0
    s_cbranch_vccz L_h1got_6
    s_mov_b32 s48, 0
    s_waitcnt vmcnt(0)
    v_cmp_ne_u64 vcc, s[42:43], v[128:129]
    s_nop 0
    s_cbranch_vccz L_h1got_6
    s_sub_u32 s50, s50, 1
    s_cbranch_scc0 L_h1slowtop_8
    s_mov_b32 s49, 0
    s_or_b32 s72, s72, 1
    s_branch L_h1got_6
L_slowst_9:
    s_mov_b32 exec_hi, 0xffff
    buffer_store_dwordx4 v[62:65], v1, s[28:31], s78 offen sc1
    s_mov_b64 exec, -1
    s_branch L_joinst_10
L_slowst_12:
    buffer_store_dwordx2 v[18:19], off, s[28:31], s40 offset:0 sc1
    s_branch L_joinst_13
L_slowst_14:
    s_mov_b32 exec_lo, s41
    s_mov_b32 exec_hi, s41
    buffer_store_dwordx2 v[174:175], v176, s[28:31], s51 offen sc1
    s_mov_b64 exec, -1
    s_branch L_joinst_15
L_slowst_25:
    buffer_store_dwordx4 v[132:135], v7, s[28:31], s51 offen offset:0 sc1
    s_branch L_joinst_26
L_slowst_27:
    buffer_store_dwordx4 v[136:139], v7, s[28:31], s51 offen offset:256 sc1
    s_branch L_joinst_28
L_slowst_29:
    s_mov_b64 exec, 1
    buffer_store_dwordx2 v[18:19], off, s[28:31], s3 offset:0 sc1
    s_mov_b64 exec, -1
    s_branch L_joinst_30
L_slowst_31:
    s_mov_b32 exec_lo, s41
    s_mov_b32 exec_hi, s41
    buffer_store_dword v108, v5, s[28:31], s18 offen sc1
    s_mov_b64 exec, -1
    s_branch L_joinst_32
L_retry_36:
    s_mov_b32 s50, s49
L_retrytop_38:
    buffer_load_dwordx2 v[172:173], v189, s[28:31], s18 offen sc1
    s_waitcnt vmcnt(0)
    v_max_u32 v180, v172, v173
    v_cmp_eq_u32 vcc, -1, v180
    s_nop 0
    s_cbranch_vccz L_retryjoin_37
    s_sub_u32 s50, s50, 1
    s_cbranch_scc0 L_retrytop_38
    s_mov_b32 s49, 0
    s_or_b32 s72, s72, 16
    s_branch L_retryjoin_37
L_slowst_39:
    buffer_store_dwordx2 v[84:85], v8, s[28:31], s36 offen offset:0 sc1
    buffer_store_dwordx2 v[86:87], v8, s[28:31], s36 offen offset:256 sc1
    s_branch L_joinst_40
L_slowst_41:
    buffer_store_dwordx2 v[88:89], v8, s[28:31], s37 offen offset:0 sc1
    buffer_store_dwordx2 v[90:91], v8, s[28:31], s37 offen offset:256 sc1
    s_branch L_joinst_42
L_slowst_46:
    s_mov_b32 exec_lo, 0x00ff00ff
    s_mov_b32 exec_hi, 0x0000ffff
    buffer_store_dwordx2 v[164:165], v10, s[28:31], s11 offen sc1
    s_mov_b64 exec, -1
    s_branch L_joinst_47
L_retry_51:
    s_mov_b32 s50, s49
L_retrytop_53:
    buffer_load_dwordx4 v[92:95], v1, s[28:31], s15 offen offset:0 sc1
    buffer_load_dwordx4 v[96:99], v1, s[28:31], s15 offen offset:1024 sc1
    buffer_load_dwordx4 v[100:103], v1, s[28:31], s15 offen offset:2048 sc1
    buffer_load_dwordx4 v[104:107], v1, s[28:31], s15 offen offset:3072 sc1
    buffer_load_dwordx4 v[124:127], v1, s[28:31], s13 offen offset:0 sc1
    buffer_load_dwordx4 v[128:131], v1, s[28:31], s13 offen offset:1024 sc1
    buffer_load_dwordx4 v[132:135], v1, s[28:31], s13 offen offset:2048 sc1
    buffer_load_dwordx4 v[136:139], v1, s[28:31], s13 offen offset:3072 sc1
    s_waitcnt vmcnt(6)
    v_or3_b32 v187, v93, v95, v97
    s_waitcnt vmcnt(5)
    v_or3_b32 v187, v187, v99, v101
    s_waitcnt vmcnt(4)
    v_or3_b32 v187, v187, v103, v105
    v_or_b32 v187, v187, v107
    v_ashrrev_i32 v187, 31, v187
    s_waitcnt vmcnt(3)
    v_max3_u32 v186, v187, v124, v126
    s_waitcnt vmcnt(2)
    v_max3_u32 v186, v186, v128, v130
    s_waitcnt vmcnt(1)
    v_max3_u32 v186, v186, v132, v134
    s_waitcnt vmcnt(0)
    v_max3_u32 v186, v186, v136, v138
    v_cmp_eq_u32 vcc, -1, v186
    s_nop 0
    s_cbranch_vccz L_retryjoin_52
    s_sub_u32 s50, s50, 1
    s_cbranch_scc0 L_retrytop_53
    s_mov_b32 s49, 0
    s_or_b32 s72, s72, 1024
    s_branch L_retryjoin_52
L_slowst_54:
    s_mov_b32 exec_lo, s41
    s_mov_b32 exec_hi, s41
    buffer_store_dword v76, v5, s[28:31], s19 offen sc1
    s_mov_b64 exec, -1
    s_branch L_joinst_55
L_slowst_58:
    buffer_store_dwordx4 v[132:135], v7, s[28:31], s51 offen offset:0 sc1
    s_branch L_joinst_59
L_slowst_60:
    buffer_store_dwordx4 v[136:139], v7, s[28:31], s51 offen offset:256 sc1
    s_branch L_joinst_61
L_slowst_62:
    s_mov_b64 exec, 1
    buffer_store_dwordx2 v[18:19], off, s[28:31], s3 offset:1024 sc1
    s_mov_b64 exec, -1
    s_branch L_joinst_63
L_slowst_64:
    s_mov_b32 exec_lo, s41
    s_mov_b32 exec_hi, s41
    buffer_store_dword v108, v5, s[28:31], s18 offen sc1
    s_mov_b64 exec, -1
    s_branch L_joinst_65
L_retry_69:
    s_mov_b32 s50, s49
L_retrytop_71:
    buffer_load_dwordx2 v[172:173], v189, s[28:31], s18 offen sc1
    s_waitcnt vmcnt(0)
    v_max_u32 v180, v172, v173
    v_cmp_eq_u32 vcc, -1, v180
    s_nop 0
    s_cbranch_vccz L_retryjoin_70
    s_sub_u32 s50, s50, 1
    s_cbranch_scc0 L_retrytop_71
    s_mov_b32 s49, 0
    s_or_b32 s72, s72, 16
    s_branch L_retryjoin_70
L_slowst_73:
    buffer_store_dwordx2 v[84:85], v8, s[28:31], s36 offen offset:0 sc1
    buffer_store_dwordx2 v[86:87], v8, s[28:31], s36 offen offset:256 sc1
    s_branch L_joinst_74
L_slowst_75:
    buffer_store_dwordx2 v[88:89], v8, s[28:31], s37 offen offset:0 sc1
    buffer_store_dwordx2 v[90:91], v8, s[28:31], s37 offen offset:256 sc1
    s_branch L_joinst_76
L_slowst_80:
    s_mov_b32 exec_lo, 0x00ff00ff
    s_mov_b32 exec_hi, 0x0000ffff
    buffer_store_dwordx2 v[164:165], v10, s[28:31], s11 offen sc1
    s_mov_b64 exec, -1
    s_branch L_joinst_81
L_retry_85:
    s_mov_b32 s50, s49
L_retrytop_87:
    buffer_load_dwordx4 v[92:95], v1, s[28:31], s15 offen offset:0 sc1
    buffer_load_dwordx4 v[96:99], v1, s[28:31], s15 offen offset:1024 sc1
    buffer_load_dwordx4 v[100:103], v1, s[28:31], s15 offen offset:2048 sc1
    buffer_load_dwordx4 v[104:107], v1, s[28:31], s15 offen offset:3072 sc1
    buffer_load_dwordx4 v[124:127], v1, s[28:31], s13 offen offset:0 sc1
    buffer_load_dwordx4 v[128:131], v1, s[28:31], s13 offen offset:1024 sc1
    buffer_load_dwordx4 v[132:135], v1, s[28:31], s13 offen offset:2048 sc1
    buffer_load_dwordx4 v[136:139], v1, s[28:31], s13 offen offset:3072 sc1
    s_waitcnt vmcnt(6)
    v_or3_b32 v187, v93, v95, v97
    s_waitcnt vmcnt(5)
    v_or3_b32 v187, v187, v99, v101
    s_waitcnt vmcnt(4)
    v_or3_b32 v187, v187, v103, v105
    v_or_b32 v187, v187, v107
    v_ashrrev_i32 v187, 31, v187
    s_waitcnt vmcnt(3)
    v_max3_u32 v186, v187, v124, v126
    s_waitcnt vmcnt(2)
    v_max3_u32 v186, v186, v128, v130
    s_waitcnt vmcnt(1)
    v_max3_u32 v186, v186, v132, v134
    s_waitcnt vmcnt(0)
    v_max3_u32 v186, v186, v136, v138
    v_cmp_eq_u32 vcc, -1, v186
    s_nop 0
    s_cbranch_vccz L_retryjoin_86
    s_sub_u32 s50, s50, 1
    s_cbranch_scc0 L_retrytop_87
    s_mov_b32 s49, 0
    s_or_b32 s72, s72, 1024
    s_branch L_retryjoin_86
L_exit:
    s_endpgm
.section .rodata,"a"
.p2align 6
.amdhsa_kernel interleave_layers__ssm_conv_h3__linear_attn_block__prompt_kernel
  .amdhsa_next_free_vgpr 512
  .amdhsa_next_free_sgpr 102
  .amdhsa_accum_offset 256
  .amdhsa_group_segment_fixed_size 0
  .amdhsa_kernarg_size 96
  .amdhsa_user_sgpr_count 2
  .amdhsa_user_sgpr_kernarg_segment_ptr 1
  .amdhsa_system_sgpr_workgroup_id_x 1
  .amdhsa_float_denorm_mode_32 3
.end_amdhsa_kernel
```
